```python
import torch

def _softmax(x, axis=-1):
    return torch.softmax(x, dim=axis)
def _gelu(x):
    return torch.nn.functional.gelu(x, approximate="tanh")
def _silu(x):
    return torch.nn.functional.silu(x)
def _sigmoid(x):
    return torch.sigmoid(x)
def _layernorm(x, axis=-1, eps=1e-5):
    m = x.mean(dim=axis, keepdim=True)
    v = x.var(dim=axis, keepdim=True, unbiased=False)
    return (x - m) / torch.sqrt(v + eps)
def _scatter_add(tgt, idx, src, axis=0):
    return tgt.clone().index_add_(axis, idx, src)
def _segment_sum(src, seg, n):
    out = torch.zeros((n,) + src.shape[1:], dtype=src.dtype)
    return out.index_add_(0, seg, src)
def _pad(x, pw):
    flat = tuple(v for pair in reversed(pw) for v in pair)
    return torch.nn.functional.pad(x, flat)

kernel_name = 'concat_heads__spectral_gfnet__ssm_conv_s4__prompt'

def setup_inputs():

    _w = (lambda a: (lambda t: t.to(torch.bfloat16) if t.is_floating_point() else t)(torch.as_tensor(a)))
    def _A_setup():
        B, S, D = 1, 2048, 512
        Df = D // 2 + 1
        return {
            "x": _w((lambda *s: torch.randn(*s, dtype=torch.bfloat16) * 0.05)(B, S, D)),
            "w_r": _w((lambda *s: torch.randn(*s, dtype=torch.bfloat16) * 0.8)(S, Df) * 0.02),
            "w_i": _w((lambda *s: torch.randn(*s, dtype=torch.bfloat16) * 0.8)(S, Df) * 0.02),
        }
    _A_in = _A_setup()

    def _B_setup():
        B, L, D, N = 1, 2048, 512, 128
        A_re = -(lambda _x: torch.exp(torch.as_tensor(_x)))((lambda *s: torch.randn(*s, dtype=torch.bfloat16) * 3.2)(D, N))
        A_im = torch.pi * (lambda *s: torch.randn(*s, dtype=torch.bfloat16) * 0.05)(D, N)
        B_re = (lambda *s: torch.randn(*s, dtype=torch.bfloat16) * 0.1)(D, N)
        B_im = (lambda *s: torch.randn(*s, dtype=torch.bfloat16) * 0.1)(D, N)
        C_re = (lambda *s: torch.randn(*s, dtype=torch.bfloat16) * 0.1)(D, N)
        C_im = (lambda *s: torch.randn(*s, dtype=torch.bfloat16) * 0.1)(D, N)
        log_dt = (lambda *s: torch.randn(*s, dtype=torch.bfloat16) * 0.05)(D) * 0.5 - 4.0
        Dskip = (lambda *s: torch.randn(*s, dtype=torch.bfloat16) * 0.05)(D)
        return {
            "u": _w((lambda *s: torch.randn(*s, dtype=torch.bfloat16) * 0.05)(B, L, D)),
            "A_re": _w(A_re),
            "A_im": _w(A_im),
            "B_re": _w(B_re),
            "B_im": _w(B_im),
            "C_re": _w(C_re),
            "C_im": _w(C_im),
            "log_dt": _w(log_dt),
            "Dskip": _w(Dskip),
        }
    _B_in = _B_setup()

    return {
        "A_x": _A_in["x"],
        "A_w_r": _A_in["w_r"],
        "A_w_i": _A_in["w_i"],
        "B_u": _B_in["u"],
        "B_A_re": _B_in["A_re"],
        "B_A_im": _B_in["A_im"],
        "B_B_re": _B_in["B_re"],
        "B_B_im": _B_in["B_im"],
        "B_C_re": _B_in["C_re"],
        "B_C_im": _B_in["C_im"],
        "B_log_dt": _B_in["log_dt"],
        "B_Dskip": _B_in["Dskip"],
    }

def reference(A_x, A_w_r, A_w_i, B_u, B_A_re, B_A_im, B_B_re, B_B_im, B_C_re, B_C_im, B_log_dt, B_Dskip):
    def _A_ref(x, w_r, w_i):
        B, S, D = x.shape
        X = (lambda x, axes=(-2,-1): torch.fft.rfft2(x.float(), dim=axes))(x, axes=(-2, -1))
        W = w_r + 1j * w_i
        X = X * W
        y = (lambda x, s, axes=(-2,-1): torch.fft.irfft2(x, s=s, dim=axes).to(torch.bfloat16))(X, (S, D), axes=(-2, -1))
        return y

    def _B_ref(u, A_re, A_im, B_re, B_im, C_re, C_im, log_dt, Dskip):
        Bsz, L, D = u.shape
        dt = torch.exp(log_dt)[:, None]
        A = A_re + 1j * A_im
        Bc = B_re + 1j * B_im
        Cc = C_re + 1j * C_im
        logdA = dt * A
        dB = dt * Bc
        l = (lambda x, dt: x.to(dt))(torch.arange(L), A_re.dtype)
        P = torch.exp(logdA[:, :, None] * l[None, None, :])
        K = torch.einsum("dn,dnl,dn->dl", Cc, P, dB).real
        L2 = 2 * L
        Kp = _pad(K, ((0, 0), (0, L)))
        up = (lambda x, *d: x.permute(*d))(u, 0, 2, 1)
        up = _pad(up, ((0, 0), (0, 0), (0, L)))
        Kf = (lambda x, axes=(-2,-1): torch.fft.rfft2(x.float(), dim=axes))(Kp[:, None, :], axes=(-2, -1))
        Uf = (lambda x, axes=(-2,-1): torch.fft.rfft2(x.float(), dim=axes))(up[:, :, None, :], axes=(-2, -1))
        Yf = Uf * Kf[None, :, :, :]
        y = (lambda x, s, axes=(-2,-1): torch.fft.irfft2(x, s=s, dim=axes).to(torch.bfloat16))(Yf, (1, L2), axes=(-2, -1))[:, :, 0, :L]
        y = (lambda x, *d: x.permute(*d))(y, 0, 2, 1) + u * Dskip[None, None, :]
        return y

    a = _A_ref(A_x, A_w_r, A_w_i)
    b = _B_ref(B_u, B_A_re, B_A_im, B_B_re, B_B_im, B_C_re, B_C_im, B_log_dt, B_Dskip)
    return torch.concatenate([a, b], axis=-1)
```

```asm
; @launch grid=(512,1,1) block=(512,1,1) lds=78208
.amdgcn_target "amdgcn-amd-amdhsa--gfx950"
.text
.globl concat_heads__spectral_gfnet__ssm_conv_s4__prompt_kernel
.p2align 8
.type concat_heads__spectral_gfnet__ssm_conv_s4__prompt_kernel,@function
concat_heads__spectral_gfnet__ssm_conv_s4__prompt_kernel:
    s_load_dwordx2 s[8:9], s[0:1], 112
    s_getpc_b64 s[72:73]
    s_cmp_lt_u32 s2, 32
    s_cselect_b32 s74, Lcode_end-concat_heads__spectral_gfnet__ssm_conv_s4__prompt_kernel, 0
    s_mov_b32 s75, 0x20000
    v_lshlrev_b32 v127, 7, v0
    buffer_load_dword v127, v127, s[72:75], 0 offen
    s_xor_b32 s2, s2, 256
    s_cmp_lt_u32 s2, 128
    s_cselect_b32 s3, 24, 0
    s_load_dwordx2 s[4:5], s[0:1], s3
    s_load_dwordx16 s[56:71], s[0:1], 32
    s_load_dwordx4 s[76:79], s[0:1], 8
    s_setprio 3
    v_readfirstlane_b32 s24, v0
    v_lshlrev_b32 v14, 4, v0
    v_and_b32 v2, 15, v0
    v_bfe_u32 v3, v0, 4, 2
    v_and_b32 v1, 0x3f0, v14
    s_mov_b32 s6, 0x200000
    s_mov_b32 s7, 0x20000
    s_cbranch_scc1 L_T
    s_cmp_lt_u32 s2, 256
    s_cbranch_scc1 L_A
    s_cmp_ge_u32 s2, 512
    s_cbranch_scc1 L_end
    s_sub_u32 s25, s2, 256
    s_lshl_b32 s3, s25, 9
    v_and_b32 v6, 255, v0
    v_lshl_add_u32 v5, v6, 1, s3
    s_lshl_b32 s3, s25, 2
    s_cmp_ge_u32 s24, 256
    v_mov_b32 v16, 0
    v_mov_b32 v17, 0
    v_mov_b32 v18, 0
    v_mov_b32 v19, 0
    v_mov_b32 v20, 0
    v_mov_b32 v21, 0
    s_waitcnt lgkmcnt(0)
    s_load_dword s30, s[68:69], s3
    s_load_dword s31, s[70:71], s3
    s_load_dwordx4 s[16:19], s[0:1], 8
    global_load_short_d16_hi v16, v5, s[56:57] nt
    global_load_short_d16_hi v17, v5, s[58:59] nt
    s_cbranch_scc1 L_type2
    global_load_short_d16_hi v18, v5, s[60:61] nt
    global_load_short_d16_hi v19, v5, s[62:63] nt
    global_load_short_d16_hi v20, v5, s[64:65] nt
    global_load_short_d16_hi v21, v5, s[66:67] nt
    s_branch L_type2
L_T:
    s_lshr_b32 s24, s24, 6
    s_lshr_b32 s31, s2, 4
    s_and_b32 s32, s2, 15
    v_lshrrev_b32 v4, 3, v0
    v_and_b32 v5, 2, v4
    v_lshrrev_b32 v6, 4, v0
    v_and_b32 v6, 4, v6
    v_or_b32 v5, v5, v6
    v_xor_b32 v5, v5, v0
    v_and_b32 v5, 7, v5
    v_lshlrev_b32 v5, 4, v5
    v_lshl_add_u32 v6, v4, 10, v5
    s_lshl_b32 s36, s32, 17
    s_lshl_b32 s3, s31, 7
    s_add_u32 s36, s36, s3
    s_add_u32 s37, s36, 0x10000
    s_lshl_b32 s38, s24, 10
    s_add_u32 s38, s38, 54272
    s_mov_b32 m0, s38
    s_waitcnt lgkmcnt(0)
    buffer_load_dwordx4 v6, s[4:7], s36 offen nt lds
    s_add_u32 m0, s38, 8192
    s_nop 0
    buffer_load_dwordx4 v6, s[4:7], s37 offen nt lds
L_T2:
    s_load_dwordx2 s[12:13], s[0:1], 96
    s_mov_b32 s10, 0x491000
    s_mov_b32 s11, 0x20000
    s_mov_b32 s14, 0x400000
    s_mov_b32 s15, 0x20000
    s_lshl_b32 s3, s31, 7
    s_add_u32 s49, s3, 0x490080
    s_mov_b32 s3, 0x490000
    s_lshr_b32 s33, s24, 1
    s_and_b32 s34, s24, 1
    s_lshl_b32 s32, s32, 2
    s_add_u32 s32, s32, s33
    s_lshl_b32 s35, s31, 1
    s_add_u32 s35, s35, s34
    v_bfe_u32 v4, v0, 3, 3
    v_and_b32 v5, 0x70, v14
    v_lshl_add_u32 v27, v4, 13, v5
    s_lshl_b32 s38, s24, 11
    s_add_u32 s38, s38, 54272
    s_lshl_b32 s43, s35, 17
    s_lshl_b32 s3, s32, 6
    s_add_u32 s43, s43, s3
    v_lshrrev_b32 v8, 2, v2
    v_lshl_add_u32 v8, v3, 3, v8
    v_and_b32 v9, 3, v2
    v_lshlrev_b32 v9, 3, v9
    v_lshl_add_u32 v10, v8, 7, v9
    v_lshl_add_u32 v8, v8, 6, v9
    v_add_u32 v26, s38, v8
    v_lshlrev_b32 v8, 2, v0
    v_and_b32 v8, 0x60, v8
    s_lshl_b32 s39, s34, 6
    v_xor_b32 v8, s39, v8
    s_lshl_b32 s39, s33, 12
    s_add_u32 s39, s39, 54272
    v_add3_u32 v22, v10, v8, s39
    v_xor_b32 v23, 32, v22
    v_lshrrev_b32 v25, 1, v2
    v_lshlrev_b32 v25, 13, v25
    v_lshl_add_u32 v25, v3, 5, v25
    v_and_b32 v9, 16, v14
    v_add_u32 v25, v25, v9
    s_add_u32 s43, s43, s3
    s_add_u32 s43, s43, 0x240000
    s_add_u32 s44, s43, 0x10000
    s_mov_b32 s47, s43
    s_mov_b32 s48, s44
    s_lshl_b32 s46, s35, 9
    s_lshl_b32 s3, s32, 3
    s_add_u32 s46, s46, s3
    s_add_u32 s46, s46, 0x444000
    s_and_b32 s25, s2, 15
    s_lshr_b32 s26, s2, 4
    s_lshl_b32 s3, s24, 4
    v_add_u32 v15, s3, v14
    s_waitcnt vmcnt(0) lgkmcnt(0)
    s_barrier
    ds_read_b64_tr_b16 v[88:89], v22 offset:0
    ds_read_b64_tr_b16 v[90:91], v22 offset:512
    ds_read_b64_tr_b16 v[92:93], v23 offset:0
    ds_read_b64_tr_b16 v[94:95], v23 offset:512
    s_waitcnt lgkmcnt(2)
    buffer_store_dwordx4 v[88:91], v25, s[8:11], s43 offen sc1
    s_waitcnt lgkmcnt(0)
    buffer_store_dwordx4 v[92:95], v25, s[8:11], s44 offen sc1
    s_mov_b32 s41, 1
    s_mov_b32 s3, 0x490000
    s_load_dwordx2 s[56:57], s[8:9], s49
    s_load_dwordx2 s[58:59], s[8:9], s3
    s_setprio 0
    s_branch L_p2
L_A:
    s_lshr_b32 s24, s24, 6
    s_sub_u32 s50, s2, 128
    s_lshl_b32 s31, s24, 17
    s_lshl_b32 s3, s50, 10
    s_add_u32 s31, s31, s3
    s_add_u32 s32, s31, 0x100000
    s_lshl_b32 s33, s24, 10
    s_mov_b32 m0, s33
    s_waitcnt lgkmcnt(0)
    buffer_load_dwordx4 v1, s[4:7], s31 offen nt lds
    s_add_u32 m0, s33, 8192
    s_nop 0
    buffer_load_dwordx4 v1, s[4:7], s32 offen nt lds
L_A2:
    s_cmp_lg_u32 s24, 0
    s_cselect_b32 s41, 0x8000000, 0
    s_cselect_b32 s38, s24, 16
    s_load_dwordx2 s[12:13], s[0:1], 96
    s_mov_b32 s10, 0x491000
    s_mov_b32 s11, 0x20000
    s_mov_b32 s14, 0x400000
    s_mov_b32 s15, 0x20000
    s_sub_u32 s26, 7, s24
    s_and_b32 s3, s50, 7
    s_lshl_b32 s3, s3, 4
    s_lshr_b32 s37, s50, 3
    s_add_u32 s37, s37, s3
    s_lshl_b32 s47, s37, 3
    s_lshl_b32 s3, s26, 10
    s_add_u32 s46, s47, s3
    s_add_u32 s46, s46, 0x440000
    s_add_u32 s47, s47, 0x440000
    s_lshl_b32 s37, s37, 7
    s_lshl_b32 s3, s26, 14
    s_add_u32 s43, s37, s3
    s_lshl_b32 s36, s50, 3
    s_add_u32 s36, s36, 0x448000
    v_cvt_f32_u32 v71, v2
    v_cvt_f32_u32 v87, v3
    v_mul_f32 v87, 4.0, v87
    v_cmp_eq_u32 s[52:53], 0, v2
    v_mov_b32 v76, 0xbf803f80
    v_lshlrev_b32 v5, 4, v3
    v_lshl_add_u32 v72, v2, 6, v5
    v_add_u32 v73, 66560, v72
    v_xor_b32 v7, v2, v3
    v_and_b32 v7, 3, v7
    v_lshlrev_b32 v7, 5, v7
    v_lshl_add_u32 v7, v2, 7, v7
    v_add_u32 v74, 68608, v7
    s_cmp_lg_u32 s24, 2
    s_cbranch_scc1 L_nom1
    v_mul_f32 v4, 0x3d000000, v71
    v_mul_f32 v6, v87, v4
    v_add_f32 v8, v6, v4
    v_fma_f32 v9, 2.0, v4, v6
    v_fma_f32 v10, 2.0, v4, v8
    v_cos_f32 v116, v6
    v_sin_f32 v120, v6
    v_cos_f32 v117, v8
    v_sin_f32 v121, v8
    v_cos_f32 v118, v9
    v_sin_f32 v122, v9
    v_cos_f32 v119, v10
    v_sin_f32 v123, v10
    v_lshlrev_b32 v4, 31, v2
    v_lshrrev_b32 v5, 16, v4
    v_or_b32 v4, v4, v5
    v_cvt_pk_bf16_f32 v32, v116, v117
    v_cvt_pk_bf16_f32 v33, v118, v119
    v_cvt_pk_bf16_f32 v36, -v120, -v121
    v_cvt_pk_bf16_f32 v37, -v122, -v123
    v_cndmask_b32 v36, v36, v76, s[52:53]
    v_cndmask_b32 v37, v37, v76, s[52:53]
    v_xor_b32 v34, v32, v4
    v_xor_b32 v35, v33, v4
    v_xor_b32 v38, v36, v4
    v_xor_b32 v39, v37, v4
    ds_write_b128 v73, v[32:35]
    ds_write_b128 v73, v[36:39] offset:1024
L_nom1:
    s_cmp_lg_u32 s24, 3
    s_cbranch_scc1 L_nom3
    v_lshl_add_u32 v4, v3, 9, s50
    v_mul_u32_u24 v4, v4, v2
    v_cvt_f32_u32 v6, v4
    v_mul_f32 v6, 0x3a000000, v6
    v_mul_f32 v4, 0x3d800000, v71
    v_add_f32 v8, v6, v4
    v_fma_f32 v9, 2.0, v4, v6
    v_fma_f32 v10, 2.0, v4, v8
    v_cos_f32 v116, v6
    v_sin_f32 v120, v6
    v_cos_f32 v117, v8
    v_sin_f32 v121, v8
    v_cos_f32 v118, v9
    v_sin_f32 v122, v9
    v_cos_f32 v119, v10
    v_sin_f32 v123, v10
    v_cvt_pk_bf16_f32 v40, -v120, -v121
    v_cvt_pk_bf16_f32 v41, -v122, -v123
    v_cvt_pk_bf16_f32 v42, v116, v117
    v_cvt_pk_bf16_f32 v43, v118, v119
    v_cvt_pk_bf16_f32 v44, v120, v121
    v_cvt_pk_bf16_f32 v45, v122, v123
    ds_write_b128 v74, v[40:43]
    ds_write_b64 v74, v[44:45] offset:16
L_nom3:
    v_lshrrev_b32 v68, 1, v1
    v_add_u32 v68, s33, v68
    s_lshl_b32 s3, s24, 4
    v_add_u32 v15, s3, v14
    v_lshlrev_b32 v69, 8, v3
    v_mul_u32_u24 v4, 1040, v2
    v_add3_u32 v64, v4, v69, s3
    v_bfe_i32 v86, v2, 3, 1
    v_and_b32 v84, 0x80008000, v86
    v_xor_b32 v85, 0x80008000, v84
    v_xor_b32 v4, v2, v86
    v_and_b32 v4, 7, v4
    v_mul_u32_u24 v4, 2064, v4
    v_add_u32 v4, v4, v69
    s_and_b32 s39, s24, 1
    s_mul_i32 s39, s39, 1016
    s_lshl_b32 s40, s24, 3
    s_lshl_b32 s38, s38, 3
    s_sub_u32 s38, s39, s38
    s_add_u32 s38, s38, 256
    s_add_u32 s3, s39, s40
    s_sub_u32 s39, s39, s40
    s_add_u32 s39, s39, 192
    s_add_u32 s40, s3, 64
    v_cmp_gt_u32 vcc, 8, v2
    v_mov_b32 v5, s38
    v_mov_b32 v6, s3
    v_mov_b32 v7, s39
    v_mov_b32 v8, s40
    v_cndmask_b32 v5, v5, v6, vcc
    v_cndmask_b32 v7, v7, v8, vcc
    v_add_u32 v65, v4, v5
    v_add_u32 v66, v4, v7
    v_and_b32 v4, 0x1cf, v0
    v_cmp_ne_u32 vcc, 0x1c0, v4
    s_nop 1
    v_cndmask_b32 v67, 0, -1, vcc
    v_lshl_add_u32 v5, v2, 5, s24
    v_add_u32 v4, 8, v5
    v_cvt_f32_u32 v4, v4
    v_mul_f32 v4, 0x3b000000, v4
    v_mul_f32 v6, v87, v4
    v_add_f32 v8, v6, v4
    v_fma_f32 v9, 2.0, v4, v6
    v_fma_f32 v10, 2.0, v4, v8
    v_cos_f32 v116, v6
    v_sin_f32 v120, v6
    v_cos_f32 v117, v8
    v_sin_f32 v121, v8
    v_cos_f32 v118, v9
    v_sin_f32 v122, v9
    v_cos_f32 v119, v10
    v_sin_f32 v123, v10
    s_cmp_eq_u32 s24, 0
    s_cselect_b32 s3, 16, 0
    v_and_b32 v4, s3, v86
    v_add_u32 v4, v4, v5
    v_cvt_f32_u32 v4, v4
    v_mul_f32 v4, 0x3b000000, v4
    v_mul_f32 v6, v87, v4
    v_cvt_pk_bf16_f32 v56, v116, v117
    v_cvt_pk_bf16_f32 v57, v118, v119
    v_cvt_pk_bf16_f32 v58, v120, v121
    v_cvt_pk_bf16_f32 v59, v122, v123
    v_add_f32 v8, v6, v4
    v_fma_f32 v9, 2.0, v4, v6
    v_fma_f32 v10, 2.0, v4, v8
    v_cos_f32 v116, v6
    v_sin_f32 v120, v6
    v_cos_f32 v117, v8
    v_sin_f32 v121, v8
    v_cos_f32 v118, v9
    v_sin_f32 v122, v9
    v_cos_f32 v119, v10
    v_sin_f32 v123, v10
    v_xor_b32 v60, v58, v85
    v_xor_b32 v61, v59, v85
    v_xor_b32 v62, v56, v84
    v_xor_b32 v63, v57, v84
    v_cvt_pk_bf16_f32 v48, v116, v117
    v_cvt_pk_bf16_f32 v49, v118, v119
    v_cvt_pk_bf16_f32 v50, v120, v121
    v_cvt_pk_bf16_f32 v51, v122, v123
    v_xor_b32 v52, v50, v85
    v_xor_b32 v53, v51, v85
    v_xor_b32 v54, v48, v84
    v_xor_b32 v55, v49, v84
    s_cbranch_scc0 L_p1_m2
    v_cndmask_b32 v52, v52, v76, s[52:53]
    v_cndmask_b32 v53, v53, v76, s[52:53]
    v_and_b32 v50, v48, v86
    v_xor_b32 v48, v48, v50
    v_and_b32 v51, v49, v86
    v_xor_b32 v49, v49, v51
    v_and_b32 v54, v52, v86
    v_xor_b32 v52, v52, v54
    v_and_b32 v55, v53, v86
    v_xor_b32 v53, v53, v55
L_p1_m2:
    s_waitcnt lgkmcnt(0)
    s_barrier
    ds_read_b128 v[32:35], v73
    ds_read_b128 v[36:39], v73 offset:1024
    ds_read_b128 v[40:43], v74
    ds_read_b64 v[44:45], v74 offset:16
    s_and_b32 s74, s2, 0x78
    s_add_u32 s74, s74, s24
    s_lshl_b32 s74, s74, 3
    s_and_b32 s75, s2, 7
    s_add_u32 s74, s74, s75
    s_mul_i32 s74, s74, 1028
    v_lshrrev_b32 v126, 7, v1
    v_and_b32 v126, 4, v126
    v_add3_u32 v127, s74, v1, v126
    global_load_dwordx4 v[28:31], v127, s[76:77] nt
    global_load_dwordx4 v[28:31], v127, s[78:79] nt
    s_mul_i32 s3, s26, 2064
    v_add_u32 v70, s3, v1
    v_mul_u32_u24 v16, 524288, v3
    v_lshl_add_u32 v16, v2, 3, v16
    v_add_u32 v17, 131072, v16
    v_add_u32 v18, 262144, v16
    v_add_u32 v19, 393216, v16
    v_mov_b32 v98, 0
    v_mov_b32 v99, 0
    v_lshlrev_b32 v10, 13, v2
    v_lshlrev_b32 v26, 11, v3
    s_waitcnt vmcnt(2) lgkmcnt(0)
    ds_read_b64_tr_b16 v[88:89], v68
    ds_read_b64_tr_b16 v[90:91], v68 offset:512
    ds_read_b64_tr_b16 v[92:93], v68 offset:8192
    ds_read_b64_tr_b16 v[94:95], v68 offset:8704
    s_waitcnt lgkmcnt(2)
    v_mfma_f32_16x16x32_bf16 v[100:103], v[88:91], v[32:35], 0
    v_mfma_f32_16x16x32_bf16 v[104:107], v[88:91], v[36:39], 0
    s_waitcnt lgkmcnt(0)
    v_mfma_f32_16x16x32_bf16 v[108:111], v[92:95], v[32:35], 0
    v_mfma_f32_16x16x32_bf16 v[112:115], v[92:95], v[36:39], 0
    s_nop 3
    v_cvt_pk_bf16_f32 v88, v100, v101
    v_cvt_pk_bf16_f32 v89, v102, v103
    v_cvt_pk_bf16_f32 v90, v104, v105
    v_cvt_pk_bf16_f32 v91, v106, v107
    ds_write_b128 v64, v[88:91] offset:16384
    v_cvt_pk_bf16_f32 v92, v108, v109
    v_cvt_pk_bf16_f32 v93, v110, v111
    v_cvt_pk_bf16_f32 v94, v112, v113
    v_cvt_pk_bf16_f32 v95, v114, v115
    ds_write_b128 v64, v[92:95] offset:16512
    s_waitcnt lgkmcnt(0)
    s_barrier
    ds_read_b128 v[88:91], v15 offset:16384
    ds_read_b128 v[92:95], v15 offset:24704
    s_waitcnt lgkmcnt(1)
    v_mfma_f32_16x16x32_bf16 v[100:103], v[88:91], v[48:51], 0
    v_mfma_f32_16x16x32_bf16 v[104:107], v[88:91], v[52:55], 0
    s_waitcnt lgkmcnt(0)
    v_mfma_f32_16x16x32_bf16 v[108:111], v[92:95], v[56:59], 0
    v_mfma_f32_16x16x32_bf16 v[112:115], v[92:95], v[60:63], 0
    s_nop 3
    v_cvt_pk_bf16_f32 v88, v100, v101
    v_cvt_pk_bf16_f32 v89, v102, v103
    v_cvt_pk_bf16_f32 v90, v104, v105
    v_cvt_pk_bf16_f32 v91, v106, v107
    ds_write_b128 v65, v[88:91] offset:33792
    v_cvt_pk_bf16_f32 v92, v108, v109
    v_cvt_pk_bf16_f32 v93, v110, v111
    v_cvt_pk_bf16_f32 v94, v112, v113
    v_cvt_pk_bf16_f32 v95, v114, v115
    ds_write_b128 v66, v[92:95] offset:33792
    s_waitcnt lgkmcnt(0)
    s_barrier
    ds_read_b128 v[92:95], v70 offset:34816
    ds_read_b128 v[88:91], v70 offset:33792
    ds_read_b64 v[96:97], v69 offset:33800
    s_waitcnt lgkmcnt(2)
    v_mfma_f32_16x16x32_bf16 v[108:111], v[42:45], v[92:95], 0
    v_mfma_f32_16x16x32_bf16 v[112:115], v[40:43], v[92:95], 0
    s_waitcnt lgkmcnt(0)
    v_and_b32 v90, v90, v67
    v_and_b32 v91, v91, v67
    s_nop 1
    v_mfma_f32_16x16x32_bf16 v[100:103], v[42:45], v[88:91], 0
    v_mfma_f32_16x16x32_bf16 v[104:107], v[40:43], v[88:91], 0
    s_cmp_lg_u32 s24, 0
    s_cbranch_scc1 L_p1_s3a
    v_mfma_f32_16x16x32_bf16 v[116:119], v[42:45], v[96:99], 0
    v_mfma_f32_16x16x32_bf16 v[120:123], v[40:43], v[96:99], 0
L_p1_s3a:
    v_cvt_pk_bf16_f32 v89, v108, v112
    v_cvt_pk_bf16_f32 v91, v109, v113
    v_cvt_pk_bf16_f32 v93, v110, v114
    v_cvt_pk_bf16_f32 v95, v111, v115
    s_nop 1
    v_cvt_pk_bf16_f32 v88, v100, v104
    v_and_b32 v88, -2, v88
    buffer_store_dwordx2 v[88:89], v16, s[8:11], s43 offen sc1
    v_cvt_pk_bf16_f32 v90, v101, v105
    v_and_b32 v90, -2, v90
    buffer_store_dwordx2 v[90:91], v17, s[8:11], s43 offen sc1
    v_cvt_pk_bf16_f32 v92, v102, v106
    v_and_b32 v92, -2, v92
    buffer_store_dwordx2 v[92:93], v18, s[8:11], s43 offen sc1
    v_cvt_pk_bf16_f32 v94, v103, v107
    v_and_b32 v94, -2, v94
    buffer_store_dwordx2 v[94:95], v19, s[8:11], s43 offen sc1
    s_cbranch_scc1 L_p1_s3b
    v_cvt_pk_bf16_f32 v76, v116, v120
    v_cvt_pk_bf16_f32 v77, v117, v121
    v_cvt_pk_bf16_f32 v78, v118, v122
    v_cvt_pk_bf16_f32 v79, v119, v123
    v_and_b32 v76, -2, v76
    v_and_b32 v77, -2, v77
    v_and_b32 v78, -2, v78
    v_and_b32 v79, -2, v79
    s_mov_b64 exec, s[52:53]
    buffer_store_dwordx2 v[76:77], v26, s[8:11], s36 offen sc1
    buffer_store_dwordx2 v[78:79], v26, s[8:11], s36 offen offset:1024 sc1
    s_mov_b64 exec, -1
L_p1_s3b:
    s_mov_b32 s3, 0x490000
    s_load_dwordx2 s[58:59], s[8:9], s3
    s_waitcnt lgkmcnt(0)
    v_lshl_add_u64 v[12:13], s[58:59], 0, 1
    s_waitcnt vmcnt(0)
    s_mov_b64 exec, 0x3
    buffer_store_dwordx2 v[12:13], v10, s[8:11], s46 offen sc1
    s_mov_b64 exec, -1
    s_lshl_b32 s3, s24, 8
    s_sub_u32 s3, s3, s50
    s_cmp_gt_i32 s3, 1784
    s_cselect_b32 s41, 1, 0
    s_cbranch_scc1 L_xhi
    s_setprio 0
L_xhi:
    s_barrier
    v_lshlrev_b32 v5, 4, v3
    v_lshl_add_u32 v4, v2, 6, v5
    s_lshl_b32 s3, s24, 12
    v_lshlrev_b32 v6, 3, v0
    v_and_b32 v6, 48, v6
    v_xor_b32 v6, v6, v4
    v_add_u32 v6, s3, v6
    v_lshlrev_b32 v7, 1, v0
    v_and_b32 v7, 48, v7
    v_xor_b32 v7, v7, v1
    v_add_u32 v25, s3, v7
    ds_write_b128 v6, v[48:51] offset:33792
    ds_write_b128 v6, v[52:55] offset:34816
    ds_write_b128 v6, v[56:59] offset:35840
    ds_write_b128 v6, v[60:63] offset:36864
    s_cmp_lg_u32 s41, 0
    s_cbranch_scc1 L_X
L_Xret:
    v_lshlrev_b32 v5, 4, v3
    s_lshl_b32 s3, s24, 14
    s_add_u32 s35, s37, s3
    v_lshlrev_b32 v24, 5, v2
    v_lshl_add_u32 v24, v3, 3, v24
    s_lshl_b32 s43, s24, 18
    s_lshl_b32 s3, s50, 11
    s_add_u32 s43, s43, s3
    s_add_u32 s44, s43, 0x200000
    v_mul_u32_u24 v4, 160, v2
    s_mul_i32 s3, s24, 2624
    s_add_u32 s3, s3, 33792
    v_add3_u32 v20, v4, v5, s3
    v_mul_u32_u24 v4, 1040, v2
    s_lshl_b32 s3, s24, 6
    s_add_u32 s3, s3, 54784
    v_add3_u32 v23, v4, v5, s3
    v_bfe_i32 v86, v3, 1, 1
    s_cmp_eq_u32 s24, 0
    s_cselect_b32 s3, 16, 0
    v_and_b32 v82, s3, v86
    v_bfe_u32 v8, v0, 2, 4
    v_lshl_add_u32 v4, v8, 5, s24
    v_add_u32 v5, 8, v4
    v_add_u32 v4, v4, v82
    v_and_b32 v6, 48, v14
    v_add_u32 v6, 33792, v6
    v_and_b32 v7, 513, v86
    v_xor_b32 v8, v8, v86
    v_and_b32 v8, 7, v8
    v_lshl_add_u32 v6, v8, 6, v6
    v_xor_b32 v4, v4, v86
    v_add_u32 v4, v4, v7
    v_mul_u32_u24 v4, 80, v4
    v_add_u32 v21, v4, v6
    v_xor_b32 v5, v5, v86
    v_add_u32 v5, v5, v7
    v_mul_u32_u24 v5, 80, v5
    v_add_u32 v22, v5, v6
L_p3a:
    s_setprio 0
    ds_read_b64_tr_b16 v[40:41], v25 offset:33792
    ds_read_b64_tr_b16 v[42:43], v25 offset:34816
    ds_read_b64_tr_b16 v[44:45], v25 offset:33800
    ds_read_b64_tr_b16 v[46:47], v25 offset:34824
    ds_read_b64_tr_b16 v[48:49], v25 offset:35840
    ds_read_b64_tr_b16 v[50:51], v25 offset:36864
    ds_read_b64_tr_b16 v[52:53], v25 offset:35848
    ds_read_b64_tr_b16 v[54:55], v25 offset:36872
    v_add_u32 v6, 66560, v1
    ds_read_b64_tr_b16 v[56:57], v6 offset:0
    ds_read_b64_tr_b16 v[58:59], v6 offset:1024
    ds_read_b64_tr_b16 v[60:61], v6 offset:8
    ds_read_b64_tr_b16 v[62:63], v6 offset:1032
    v_bfe_u32 v4, v0, 3, 1
    v_xor_b32 v5, v4, v0
    v_lshl_add_u32 v4, v3, 2, v4
    v_and_b32 v5, 3, v5
    v_lshlrev_b32 v5, 5, v5
    v_lshl_add_u32 v4, v4, 7, v5
    v_and_b32 v5, 4, v0
    v_lshlrev_b32 v5, 1, v5
    v_bitop3_b32 v4, v4, v5, 8 bitop3:0x96
    v_add_u32 v7, 68608, v4
    v_xor_b32 v8, 64, v7
    ds_read_b64_tr_b16 v[32:33], v7 offset:0
    ds_read_b64_tr_b16 v[34:35], v8 offset:256
    ds_read_b64_tr_b16 v[36:37], v7 offset:8
    ds_read_b64_tr_b16 v[38:39], v8 offset:264
    v_mov_b32 v96, 1
    v_mov_b32 v97, 1
    v_mov_b32 v98, 1
    v_mov_b32 v99, 1
    v_cmp_gt_u32 vcc, 16, v0
    v_mov_b32 v4, 0x80
    s_nop 0
    v_cndmask_b32 v4, 0, v4, vcc
    s_waitcnt lgkmcnt(0)
    v_sub_u32 v40, v40, v4
    v_sub_u32 v42, v42, v4
    s_mov_b32 s42, 1000000
    s_setprio 3
    s_waitcnt lgkmcnt(0)
    s_and_b32 s45, s50, 15
    s_mul_i32 s45, s45, 131072
    s_lshr_b32 s3, s50, 4
    s_lshl_b32 s3, s3, 14
    s_add_u32 s45, s45, s3
    s_add_u32 s45, s45, s37
L_h2ap:
    s_cmp_lg_u32 s24, 0
    s_cbranch_scc1 L_h2ap_o
    s_mov_b64 exec, 1
L_h2ap_l:
    buffer_load_dword v4, off, s[8:11], s45 offset:0 sc1
    s_waitcnt vmcnt(0)
    v_and_b32 v4, 1, v4
    v_cmp_eq_u32 vcc, 0, v4
    s_sub_u32 s42, s42, 1
    s_cbranch_scc1 L_h2ap_o
    s_cbranch_vccnz L_h2ap_l
L_h2ap_o:
    s_mov_b64 exec, -1
    s_mov_b32 s42, 1000000
    s_barrier
L_h2a:
    buffer_load_dwordx2 v[88:89], v16, s[8:11], s35 offen sc1
    buffer_load_dwordx2 v[92:93], v17, s[8:11], s35 offen sc1
    buffer_load_dwordx2 v[90:91], v18, s[8:11], s35 offen sc1
    buffer_load_dwordx2 v[94:95], v19, s[8:11], s35 offen sc1
    s_cmp_eq_u32 s24, 0
    s_cbranch_scc0 L_h2a_w
    buffer_load_dwordx2 v[96:97], v26, s[8:11], s36 offen sc1
    buffer_load_dwordx2 v[98:99], v26, s[8:11], s36 offen offset:1024 sc1
L_h2a_w:
    s_waitcnt vmcnt(0)
    v_bitop3_b32 v4, v88, v90, v92 bitop3:0x80
    v_bitop3_b32 v5, v94, v96, v97 bitop3:0x80
    v_bitop3_b32 v6, v98, v99, 1 bitop3:0x80
    v_bitop3_b32 v4, v4, v5, v6 bitop3:0x80
    v_cmp_eq_u32 vcc, 0, v4
    s_nop 0
    s_mov_b64 exec, vcc
    s_sub_u32 s42, s42, 1
    s_cbranch_scc1 L_h2a_done
    s_cbranch_vccnz L_h2a
L_h2a_done:
    s_mov_b64 exec, -1
    v_swap_b32 v89, v92
    v_swap_b32 v91, v94
    s_nop 1
    v_mfma_f32_16x16x32_bf16 v[108:111], v[32:35], v[92:95], 0
    v_mfma_f32_16x16x32_bf16 v[112:115], v[36:39], v[92:95], 0
    v_mfma_f32_16x16x32_bf16 v[100:103], v[32:35], v[88:91], 0
    v_mfma_f32_16x16x32_bf16 v[104:107], v[36:39], v[88:91], 0
    v_mfma_f32_16x16x32_bf16 v[116:119], v[32:35], v[96:99], 0
    s_nop 3
    v_cvt_pk_bf16_f32 v92, v108, v109
    v_cvt_pk_bf16_f32 v93, v110, v111
    v_cvt_pk_bf16_f32 v94, v112, v113
    v_cvt_pk_bf16_f32 v95, v114, v115
    ds_write_b128 v20, v[92:95] offset:80
    v_cvt_pk_bf16_f32 v88, v100, v101
    v_cvt_pk_bf16_f32 v89, v102, v103
    v_cvt_pk_bf16_f32 v90, v104, v105
    v_cvt_pk_bf16_f32 v91, v106, v107
    s_cmp_lg_u32 s24, 0
    s_cbranch_scc1 L_p3_a
    v_cvt_pk_bf16_f32 v96, v116, v117
    v_cvt_pk_bf16_f32 v97, v118, v119
    v_cndmask_b32 v90, v90, v96, s[52:53]
    v_cndmask_b32 v91, v91, v97, s[52:53]
L_p3_a:
    ds_write_b128 v20, v[88:91]
    s_waitcnt lgkmcnt(0)
    s_barrier
    ds_read_b64_tr_b16 v[88:89], v21
    ds_read_b64_tr_b16 v[90:91], v21 offset:8
    ds_read_b64_tr_b16 v[92:93], v22
    ds_read_b64_tr_b16 v[94:95], v22 offset:8
    s_waitcnt lgkmcnt(2)
    v_mfma_f32_16x16x32_bf16 v[100:103], v[40:43], v[88:91], 0
    v_mfma_f32_16x16x32_bf16 v[104:107], v[44:47], v[88:91], 0
    s_waitcnt lgkmcnt(0)
    v_mfma_f32_16x16x32_bf16 v[108:111], v[48:51], v[92:95], 0
    v_mfma_f32_16x16x32_bf16 v[112:115], v[52:55], v[92:95], 0
    s_nop 3
    v_cvt_pk_bf16_f32 v88, v100, v101
    v_cvt_pk_bf16_f32 v89, v102, v103
    v_cvt_pk_bf16_f32 v90, v104, v105
    v_cvt_pk_bf16_f32 v91, v106, v107
    ds_write_b128 v23, v[88:91]
    v_cvt_pk_bf16_f32 v92, v108, v109
    v_cvt_pk_bf16_f32 v93, v110, v111
    v_cvt_pk_bf16_f32 v94, v112, v113
    v_cvt_pk_bf16_f32 v95, v114, v115
    ds_write_b128 v23, v[92:95] offset:512
    s_waitcnt lgkmcnt(0)
    s_barrier
    ds_read_b64_tr_b16 v[88:89], v15 offset:54784
    ds_read_b64_tr_b16 v[90:91], v15 offset:54792
    ds_read_b64_tr_b16 v[92:93], v15 offset:63104
    ds_read_b64_tr_b16 v[94:95], v15 offset:63112
    s_waitcnt lgkmcnt(2)
    v_mfma_f32_16x16x32_bf16 v[100:103], v[88:91], v[56:59], 0
    v_mfma_f32_16x16x32_bf16 v[104:107], v[88:91], v[60:63], 0
    s_waitcnt lgkmcnt(0)
    v_mfma_f32_16x16x32_bf16 v[108:111], v[92:95], v[56:59], 0
    v_mfma_f32_16x16x32_bf16 v[112:115], v[92:95], v[60:63], 0
    s_nop 3
    v_cvt_pk_bf16_f32 v88, v100, v101
    v_cvt_pk_bf16_f32 v89, v102, v103
    v_cvt_pk_bf16_f32 v90, v104, v105
    v_cvt_pk_bf16_f32 v91, v106, v107
    buffer_store_dwordx2 v[88:89], v24, s[12:15], s43 offen sc1 nt
    buffer_store_dwordx2 v[90:91], v24, s[12:15], s43 offen offset:512 sc1 nt
    v_cvt_pk_bf16_f32 v92, v108, v109
    v_cvt_pk_bf16_f32 v93, v110, v111
    v_cvt_pk_bf16_f32 v94, v112, v113
    v_cvt_pk_bf16_f32 v95, v114, v115
    buffer_store_dwordx2 v[92:93], v24, s[12:15], s44 offen sc1 nt
    buffer_store_dwordx2 v[94:95], v24, s[12:15], s44 offen offset:512 sc1 nt
    s_or_b32 s3, s50, s24
    s_cmp_lg_u32 s3, 0
    s_cbranch_scc1 L_p3_c
    s_mov_b32 s3, 0x490000
    buffer_store_dwordx2 v[12:13], off, s[8:11], s3 sc1
L_p3_c:
    s_endpgm
L_X:
    s_setprio 3
    s_load_dwordx2 s[16:17], s[0:1], 8
    s_load_dwordx2 s[20:21], s[0:1], 16
    s_mov_b32 s18, 0x101000
    s_mov_b32 s19, 0x20000
    s_mov_b32 s22, 0x101000
    s_mov_b32 s23, 0x20000
    v_mov_b32 v64, 0
    v_mov_b32 v65, 0
    v_mov_b32 v66, 0
    v_mov_b32 v67, 0
    v_mov_b32 v68, 0
    v_mov_b32 v69, 0
    v_mov_b32 v70, 0
    v_mov_b32 v71, 0
    v_lshrrev_b32 v56, 1, v3
    v_and_b32 v57, 1, v3
    v_lshl_add_u32 v4, v2, 4, v56
    v_lshl_add_u32 v4, v57, 10, v4
    v_mul_u32_u24 v60, 514, v4
    s_mul_i32 s27, s50, 1028
    s_add_u32 s28, s27, 131584
    s_add_u32 s29, s27, 263168
    s_add_u32 s30, s27, 394752
    v_and_b32 v58, 7, v2
    v_lshrrev_b32 v59, 3, v2
    v_lshlrev_b32 v61, 8, v3
    v_lshl_add_u32 v61, v58, 3, v61
    v_lshl_add_u32 v61, v59, 2, v61
    s_lshl_b32 s74, s50, 10
    s_add_u32 s74, s74, 0x448000
    s_mov_b32 s39, 0x441c00
    v_lshrrev_b32 v11, 1, v1
    s_waitcnt lgkmcnt(0)
    buffer_load_short_d16_hi v64, v60, s[16:19], s27 offen offset:512
    buffer_load_short_d16_hi v68, v60, s[20:23], s27 offen offset:512
    buffer_load_short_d16_hi v65, v60, s[16:19], s28 offen offset:512
    buffer_load_short_d16_hi v69, v60, s[20:23], s28 offen offset:512
    buffer_load_short_d16_hi v66, v60, s[16:19], s29 offen offset:512
    buffer_load_short_d16_hi v70, v60, s[20:23], s29 offen offset:512
    buffer_load_short_d16_hi v67, v60, s[16:19], s30 offen offset:512
    buffer_load_short_d16_hi v71, v60, s[20:23], s30 offen offset:512
    v_cvt_f32_u32 v62, v2
    v_cvt_f32_u32 v63, v3
    v_cvt_f32_u32 v57, v57
    v_cvt_f32_u32 v58, v58
    v_mul_f32 v63, 4.0, v63
    v_mul_f32 v57, 4.0, v57
    v_cmp_eq_u32 vcc, v56, v59
    v_mul_f32 v4, 0x3d800000, v62
    v_mul_f32 v6, v63, v4
    v_add_f32 v8, v6, v4
    v_fma_f32 v9, 2.0, v4, v6
    v_fma_f32 v10, 2.0, v4, v8
    v_cos_f32 v116, v6
    v_sin_f32 v120, v6
    v_cos_f32 v117, v8
    v_sin_f32 v121, v8
    v_cos_f32 v118, v9
    v_sin_f32 v122, v9
    v_cos_f32 v119, v10
    v_sin_f32 v123, v10
    v_cvt_pk_bf16_f32 v32, v116, v120
    v_cvt_pk_bf16_f32 v36, -v120, v116
    v_cvt_pk_bf16_f32 v33, v117, v121
    v_cvt_pk_bf16_f32 v37, -v121, v117
    v_cvt_pk_bf16_f32 v34, v118, v122
    v_cvt_pk_bf16_f32 v38, -v122, v118
    v_cvt_pk_bf16_f32 v35, v119, v123
    v_cvt_pk_bf16_f32 v39, -v123, v119
    v_cvt_pk_bf16_f32 v50, v120, v121
    v_cvt_pk_bf16_f32 v51, v122, v123
    v_cvt_pk_bf16_f32 v52, v116, v117
    v_cvt_pk_bf16_f32 v53, v118, v119
    v_cvt_pk_bf16_f32 v54, -v120, -v121
    v_cvt_pk_bf16_f32 v55, -v122, -v123
    v_mul_f32 v4, 0x3e000000, v58
    v_mul_f32 v6, v57, v4
    v_add_f32 v8, v6, v4
    v_fma_f32 v9, 2.0, v4, v6
    v_fma_f32 v10, 2.0, v4, v8
    v_cos_f32 v116, v6
    v_sin_f32 v120, v6
    v_cos_f32 v117, v8
    v_sin_f32 v121, v8
    v_cos_f32 v118, v9
    v_sin_f32 v122, v9
    v_cos_f32 v119, v10
    v_sin_f32 v123, v10
    v_mov_b32 v4, 0x3ab504f3
    v_cndmask_b32 v4, 0, v4, vcc
    v_mul_f32 v116, v4, v116
    v_mul_f32 v117, v4, v117
    v_mul_f32 v118, v4, v118
    v_mul_f32 v119, v4, v119
    v_mul_f32 v120, v4, v120
    v_mul_f32 v121, v4, v121
    v_mul_f32 v122, v4, v122
    v_mul_f32 v123, v4, v123
    v_cvt_pk_bf16_f32 v40, -v120, -v121
    v_cvt_pk_bf16_f32 v41, -v122, -v123
    v_cvt_pk_bf16_f32 v42, v116, v117
    v_cvt_pk_bf16_f32 v43, v118, v119
    v_cvt_pk_bf16_f32 v44, v120, v121
    v_cvt_pk_bf16_f32 v45, v122, v123
    v_cvt_pk_bf16_f32 v46, v116, v117
    v_cvt_pk_bf16_f32 v47, v118, v119
    v_cvt_pk_bf16_f32 v48, -v120, -v121
    v_cvt_pk_bf16_f32 v49, -v122, -v123
    v_mul_f32 v4, 0xbc000000, v62
    v_mul_f32 v6, v57, v4
    v_add_f32 v8, v6, v4
    v_fma_f32 v9, 2.0, v4, v6
    v_fma_f32 v10, 2.0, v4, v8
    v_cos_f32 v72, v6
    v_sin_f32 v76, v6
    v_cos_f32 v73, v8
    v_sin_f32 v77, v8
    v_cos_f32 v74, v9
    v_sin_f32 v78, v9
    v_cos_f32 v75, v10
    v_sin_f32 v79, v10
    v_mul_f32 v4, 0x3c000000, v58
    v_mul_f32 v6, v63, v4
    v_add_f32 v8, v6, v4
    v_fma_f32 v9, 2.0, v4, v6
    v_fma_f32 v10, 2.0, v4, v8
    v_cos_f32 v80, v6
    v_sin_f32 v84, v6
    v_cos_f32 v81, v8
    v_sin_f32 v85, v8
    v_cos_f32 v82, v9
    v_sin_f32 v86, v9
    v_cos_f32 v83, v10
    v_sin_f32 v87, v10
    s_mov_b32 s42, 1000000
L_Xp:
    v_mov_b32 v4, 0
    v_mov_b32 v5, 0
    v_mov_b32 v6, 0
    v_mov_b32 v7, 0
    buffer_atomic_or_x2 v[4:5], v11, s[8:11], s39 offen sc0 sc1
    buffer_atomic_or_x2 v[6:7], v11, s[8:11], s39 offen offset:512 sc0 sc1
    s_waitcnt vmcnt(0)
    v_cmp_ne_u64 vcc, v[4:5], v[12:13]
    v_cmp_ne_u64 s[40:41], v[6:7], v[12:13]
    s_nop 0
    s_or_b64 vcc, vcc, s[40:41]
    s_sub_u32 s42, s42, 1
    s_cbranch_scc1 L_Xq
    s_cbranch_vccnz L_Xp
L_Xq:
    buffer_load_dword v88, v61, s[8:11], s74 offen offset:0 sc1
    buffer_load_dword v89, v61, s[8:11], s74 offen offset:64 sc1
    buffer_load_dword v90, v61, s[8:11], s74 offen offset:128 sc1
    buffer_load_dword v91, v61, s[8:11], s74 offen offset:192 sc1
    s_waitcnt vmcnt(0)
    v_mfma_f32_16x16x32_bf16 v[100:103], v[88:91], v[32:35], 0
    v_mfma_f32_16x16x32_bf16 v[104:107], v[88:91], v[36:39], 0
    s_nop 6
    v_mul_f32 v108, v100, v72
    v_mul_f32 v112, v100, v76
    v_mul_f32 v109, v101, v73
    v_mul_f32 v113, v101, v77
    v_mul_f32 v110, v102, v74
    v_mul_f32 v114, v102, v78
    v_mul_f32 v111, v103, v75
    v_mul_f32 v115, v103, v79
    v_fma_f32 v108, -v104, v76, v108
    v_fmac_f32 v112, v104, v72
    v_fma_f32 v109, -v105, v77, v109
    v_fmac_f32 v113, v105, v73
    v_fma_f32 v110, -v106, v78, v110
    v_fmac_f32 v114, v106, v74
    v_fma_f32 v111, -v107, v79, v111
    v_fmac_f32 v115, v107, v75
    v_cvt_pk_bf16_f32 v88, v108, v109
    v_cvt_pk_bf16_f32 v89, v110, v111
    v_cvt_pk_bf16_f32 v90, v112, v113
    v_cvt_pk_bf16_f32 v91, v114, v115
    s_nop 1
    v_mfma_f32_16x16x32_bf16 v[100:103], v[42:45], v[88:91], 0
    v_mfma_f32_16x16x32_bf16 v[104:107], v[40:43], v[88:91], 0
    s_nop 6
    v_mul_f32 v108, v100, v64
    v_mul_f32 v112, v100, v68
    v_mul_f32 v109, v101, v65
    v_mul_f32 v113, v101, v69
    v_mul_f32 v110, v102, v66
    v_mul_f32 v114, v102, v70
    v_mul_f32 v111, v103, v67
    v_mul_f32 v115, v103, v71
    v_fma_f32 v108, -v104, v68, v108
    v_fmac_f32 v112, v104, v64
    v_fma_f32 v109, -v105, v69, v109
    v_fmac_f32 v113, v105, v65
    v_fma_f32 v110, -v106, v70, v110
    v_fmac_f32 v114, v106, v66
    v_fma_f32 v111, -v107, v71, v111
    v_fmac_f32 v115, v107, v67
    v_cvt_pk_bf16_f32 v88, v108, v109
    v_cvt_pk_bf16_f32 v89, v110, v111
    v_cvt_pk_bf16_f32 v90, v112, v113
    v_cvt_pk_bf16_f32 v91, v114, v115
    s_nop 1
    v_mfma_f32_16x16x32_bf16 v[100:103], v[88:91], v[46:49], 0
    v_mfma_f32_16x16x32_bf16 v[104:107], v[88:91], v[44:47], 0
    s_nop 6
    v_mul_f32 v108, v100, v80
    v_mul_f32 v112, v100, v84
    v_mul_f32 v109, v101, v81
    v_mul_f32 v113, v101, v85
    v_mul_f32 v110, v102, v82
    v_mul_f32 v114, v102, v86
    v_mul_f32 v111, v103, v83
    v_mul_f32 v115, v103, v87
    v_fma_f32 v108, -v104, v84, v108
    v_fmac_f32 v112, v104, v80
    v_fma_f32 v109, -v105, v85, v109
    v_fmac_f32 v113, v105, v81
    v_fma_f32 v110, -v106, v86, v110
    v_fmac_f32 v114, v106, v82
    v_fma_f32 v111, -v107, v87, v111
    v_fmac_f32 v115, v107, v83
    v_cvt_pk_bf16_f32 v88, v108, v109
    v_cvt_pk_bf16_f32 v89, v110, v111
    v_cvt_pk_bf16_f32 v90, v112, v113
    v_cvt_pk_bf16_f32 v91, v114, v115
    s_nop 1
    v_mfma_f32_16x16x32_bf16 v[100:103], v[52:55], v[88:91], 0
    v_mfma_f32_16x16x32_bf16 v[104:107], v[50:53], v[88:91], 0
    s_nop 7
    v_cvt_pk_bf16_f32 v88, v100, v104
    v_or_b32 v88, 1, v88
    buffer_store_dword v88, v61, s[8:11], s74 offen offset:0 sc1
    v_cvt_pk_bf16_f32 v89, v101, v105
    v_or_b32 v89, 1, v89
    buffer_store_dword v89, v61, s[8:11], s74 offen offset:64 sc1
    v_cvt_pk_bf16_f32 v90, v102, v106
    v_or_b32 v90, 1, v90
    buffer_store_dword v90, v61, s[8:11], s74 offen offset:128 sc1
    v_cvt_pk_bf16_f32 v91, v103, v107
    v_or_b32 v91, 1, v91
    buffer_store_dword v91, v61, s[8:11], s74 offen offset:192 sc1
    s_branch L_Xret
L_type2:
    s_setprio 1
    s_mov_b32 s10, 0x491000
    s_mov_b32 s11, 0x20000
    s_lshr_b32 s24, s24, 6
    s_sub_u32 s33, 7, s24
    s_lshl_b32 s33, s33, 8
    s_add_u32 s33, s33, s25
    s_lshl_b32 s3, s33, 7
    s_add_u32 s3, s3, 0x440000
    s_cmp_lt_u32 s33, 320
    s_cselect_b32 s3, s3, 0x8000000
    v_lshlrev_b32 v4, 6, v2
    v_mov_b32 v120, 0
    s_mov_b64 exec, 3
    buffer_atomic_or v120, v4, s[8:11], s3 offen sc1
    s_mov_b64 exec, -1
    s_lshr_b32 s3, s25, 5
    s_lshl_b32 s3, s3, 7
    s_add_u32 s46, s3, 0x490080
    s_bfe_u32 s26, s24, 0x10001
    s_mul_i32 s27, s26, 29184
    s_add_u32 s27, s27, 18816
    s_mul_i32 s28, s26, 9408
    s_and_b32 s29, s24, 1
    s_lshr_b32 s32, s24, 2
    s_lshl_b32 s3, s32, 1
    s_add_u32 s29, s29, s3
    v_bfe_u32 v4, v0, 2, 5
    v_mul_u32_u24 v4, 912, v4
    v_and_b32 v7, 3, v0
    v_lshl_add_u32 v4, v7, 2, v4
    v_add_u32 v24, s27, v4
    v_bfrev_b32 v4, v3
    v_lshrrev_b32 v4, 27, v4
    v_mul_u32_u24 v4, 912, v4
    v_lshl_add_u32 v4, v2, 4, v4
    v_add_u32 v25, s27, v4
    s_lshl_b32 s3, s29, 8
    v_add_u32 v26, s3, v25
    v_and_b32 v7, 1, v2
    v_mul_u32_u24 v4, 9408, v7
    v_lshrrev_b32 v47, 1, v0
    v_lshl_add_u32 v15, v47, 4, v4
    v_mov_b32 v120, 0
    v_mov_b32 v121, 0
    v_mov_b32 v122, 0
    v_mov_b32 v123, 0
    v_cmp_gt_u32 vcc, 72, v0
    s_nop 0
    s_and_saveexec_b64 s[40:41], vcc
    ds_write_b128 v15, v[120:123]
    ds_write_b128 v15, v[120:123] offset:4704
    s_mov_b64 exec, -1
    s_lshl_b32 s44, s25, 13
    s_add_u32 s45, s44, 0x240000
    s_add_u32 s44, s44, 0x240000
    v_lshrrev_b32 v22, 1, v1
    s_cmp_ge_u32 s24, 4
    s_cbranch_scc1 L_sh
    v_and_b32 v4, 3, v2
    v_mul_u32_u24 v4, 4160, v4
    v_lshrrev_b32 v10, 2, v2
    v_sub_u32 v10, v3, v10
    v_lshl_add_u32 v4, v10, 4, v4
    s_add_u32 s3, s27, 2032
    v_add_u32 v28, s3, v4
    v_lshrrev_b32 v4, 1, v2
    v_lshlrev_b32 v4, 6, v4
    v_lshl_add_u32 v4, v3, 4, v4
    v_mul_u32_u24 v10, 4704, v7
    s_add_u32 s3, s28, 128
    v_add3_u32 v29, v4, v10, s3
    v_lshl_add_u32 v43, v7, 3, v4
    v_lshl_add_u32 v27, v43, 1, s27
    v_and_b32 v10, 0x1c0, v4
    v_add_u32 v30, v43, v10
    v_or_b32 v6, 128, v6
    v_lshl_add_u32 v31, v6, 4, s27
    v_lshlrev_b32 v4, 3, v6
    v_sub_u32 v4, 2047, v4
    v_max_u32 v5, 143, v4
    v_sub_u32 v4, v4, v5
    v_cvt_f32_u32 v5, v5
    s_add_u32 s3, s28, -67520
    v_mov_b32 v9, s28
    v_lshl_add_u32 v4, v4, 2, s3
    v_subrev_f32 v7, 0x00000000, v5
    v_subrev_f32 v8, 0x3f800000, v5
    v_cvt_pk_bf16_f32 v7, v7, v8
    v_and_b32 v8, 0xffff, v7
    v_lshl_add_u32 v32, v8, 2, v4
    v_lshrrev_b32 v7, 16, v7
    v_lshl_add_u32 v33, v7, 2, v4
    v_subrev_f32 v7, 0x40000000, v5
    v_subrev_f32 v8, 0x40400000, v5
    v_cvt_pk_bf16_f32 v7, v7, v8
    v_and_b32 v8, 0xffff, v7
    v_lshl_add_u32 v34, v8, 2, v4
    v_lshrrev_b32 v7, 16, v7
    v_lshl_add_u32 v35, v7, 2, v4
    v_subrev_f32 v7, 0x40800000, v5
    v_subrev_f32 v8, 0x40a00000, v5
    v_cvt_pk_bf16_f32 v7, v7, v8
    v_and_b32 v8, 0xffff, v7
    v_lshl_add_u32 v36, v8, 2, v4
    v_lshrrev_b32 v7, 16, v7
    v_lshl_add_u32 v37, v7, 2, v4
    v_subrev_f32 v7, 0x40c00000, v5
    v_subrev_f32 v8, 0x40e00000, v5
    v_cvt_pk_bf16_f32 v7, v7, v8
    v_and_b32 v8, 0xffff, v7
    v_lshl_add_u32 v38, v8, 2, v4
    v_lshrrev_b32 v7, 16, v7
    v_lshl_add_u32 v39, v7, 2, v4
    v_subrev_f32 v7, 0x41000000, v5
    v_subrev_f32 v8, 0x41100000, v5
    v_cvt_pk_bf16_f32 v7, v7, v8
    v_and_b32 v8, 0xffff, v7
    v_lshl_add_u32 v40, v8, 2, v4
    v_lshrrev_b32 v7, 16, v7
    v_lshl_add_u32 v41, v7, 2, v4
    v_subrev_f32 v7, 0x41200000, v5
    v_subrev_f32 v8, 0x41300000, v5
    v_cvt_pk_bf16_f32 v7, v7, v8
    v_and_b32 v8, 0xffff, v7
    v_lshl_add_u32 v42, v8, 2, v4
    v_cmp_eq_u32 vcc, 255, v6
    s_nop 0
    s_mov_b64 s[34:35], vcc
    v_cndmask_b32 v40, v40, v9, s[34:35]
    v_cndmask_b32 v41, v41, v9, s[34:35]
    v_cndmask_b32 v42, v42, v9, s[34:35]
    s_branch L_sh2
L_sh:
    s_lshr_b32 s39, s25, 4
    s_lshl_b32 s39, s39, 9
    s_add_u32 s39, s39, 0x444000
    v_lshlrev_b32 v8, 3, v3
    v_mov_b32 v4, 0xfe00
    v_mov_b32 v5, 0x1ff
    v_lshlrev_b32 v4, v2, v4
    v_lshlrev_b32 v5, v2, v5
    v_lshrrev_b32 v4, v8, v4
    v_lshrrev_b32 v5, v8, v5
    s_mov_b32 s3, 0xffff
    v_bfe_i32 v9, v4, 0, 1
    v_bfe_i32 v10, v4, 1, 1
    v_bfi_b32 v9, s3, v9, v10
    v_and_b32 v32, 0x3f803f80, v9
    v_bfe_i32 v9, v4, 2, 1
    v_bfe_i32 v10, v4, 3, 1
    v_bfi_b32 v9, s3, v9, v10
    v_and_b32 v33, 0x3f803f80, v9
    v_bfe_i32 v9, v4, 4, 1
    v_bfe_i32 v10, v4, 5, 1
    v_bfi_b32 v9, s3, v9, v10
    v_and_b32 v34, 0x3f803f80, v9
    v_bfe_i32 v9, v4, 6, 1
    v_bfe_i32 v10, v4, 7, 1
    v_bfi_b32 v9, s3, v9, v10
    v_and_b32 v35, 0x3f803f80, v9
    v_bfe_i32 v9, v5, 0, 1
    v_bfe_i32 v10, v5, 1, 1
    v_bfi_b32 v9, s3, v9, v10
    v_and_b32 v36, 0x3f803f80, v9
    v_bfe_i32 v9, v5, 2, 1
    v_bfe_i32 v10, v5, 3, 1
    v_bfi_b32 v9, s3, v9, v10
    v_and_b32 v37, 0x3f803f80, v9
    v_bfe_i32 v9, v5, 4, 1
    v_bfe_i32 v10, v5, 5, 1
    v_bfi_b32 v9, s3, v9, v10
    v_and_b32 v38, 0x3f803f80, v9
    v_bfe_i32 v9, v5, 6, 1
    v_bfe_i32 v10, v5, 7, 1
    v_bfi_b32 v9, s3, v9, v10
    v_and_b32 v39, 0x3f803f80, v9
    v_lshlrev_b32 v4, 2, v3
    v_sub_u32 v40, v2, v4
    s_add_u32 s3, s28, 2604
    v_lshl_add_u32 v41, v40, 3, s3
    s_and_b32 s34, s24, 1
    s_lshl_b32 s35, s34, 9
    s_sub_u32 s3, s28, s35
    s_add_u32 s3, s3, 544
    v_lshlrev_b32 v4, 4, v3
    v_lshl_add_u32 v5, v2, 5, v4
    v_add_u32 v42, s3, v5
    s_lshl_b32 s35, s34, 10
    s_sub_u32 s3, s27, s35
    v_lshl_add_u32 v5, v2, 6, v4
    v_add_u32 v43, s3, v5
    v_lshrrev_b32 v4, 2, v2
    v_and_b32 v5, 3, v2
    v_lshl_add_u32 v27, v5, 1, v4
    v_sub_u32 v4, 3, v4
    v_mul_u32_u24 v4, 4160, v4
    v_lshl_add_u32 v28, v5, 2, v4
    v_add_u32 v28, s27, v28
    v_mul_u32_u24 v4, 4160, v3
    v_min_u32 v5, 2, v5
    v_lshl_add_u32 v4, v5, 4, v4
    v_add_u32 v29, s27, v4
    v_mov_b32 v30, s28
L_sh2:
    s_waitcnt lgkmcnt(0)
    s_lshl_b32 s3, s26, 4
    s_lshr_b32 s30, s30, s3
    s_lshl_b32 s30, s30, 16
    s_lshr_b32 s31, s31, s3
    s_lshl_b32 s31, s31, 16
    v_mov_b32 v46, 0x3fb8aa3b
    v_mul_f32 v46, s30, v46
    v_exp_f32 v46, v46
    s_nop 0
    v_cvt_pk_bf16_f32 v46, v46, v46
    v_and_b32 v46, 0xffff0000, v46
    s_mov_b32 s3, 0x490000
    s_load_dwordx2 s[36:37], s[8:9], s46
    s_load_dword s40, s[8:9], s3
    s_and_b32 s3, s25, 0xf8
    s_add_u32 s3, s3, s24
    s_lshl_b32 s3, s3, 3
    s_and_b32 s33, s25, 7
    s_add_u32 s3, s3, s33
    s_mul_i32 s3, s3, 514
    s_add_u32 s3, s3, 2
    v_add_u32 v126, s3, v22
    s_cmp_ge_u32 s24, 4
    s_waitcnt vmcnt(1)
    v_mul_f32 v44, v46, v16
    v_mul_f32 v45, v46, v17
    v_mul_f32 v44, 0x3fb8aa3b, v44
    v_mul_f32 v45, 0.15915494, v45
    s_cbranch_scc1 L_kg1
    v_mul_f32 v4, 0x41000000, v44
    v_mul_f32 v5, 0x41000000, v45
    v_mul_f32 v6, 0x43000000, v44
    v_mul_f32 v7, 0x43000000, v45
    v_mul_f32 v8, 0x44800000, v44
    v_mul_f32 v9, 0x44800000, v45
    v_fract_f32 v5, v5
    v_fract_f32 v7, v7
    v_fract_f32 v9, v9
    v_exp_f32 v4, v4
    v_cos_f32 v48, v5
    v_sin_f32 v49, v5
    v_exp_f32 v6, v6
    v_cos_f32 v52, v7
    v_sin_f32 v53, v7
    v_exp_f32 v8, v8
    v_cos_f32 v96, v9
    v_sin_f32 v97, v9
    v_pk_mul_f32 v[48:49], v[48:49], v[4:5] op_sel_hi:[1,0]
    v_pk_mul_f32 v[52:53], v[52:53], v[6:7] op_sel_hi:[1,0]
    v_pk_mul_f32 v[96:97], v[96:97], v[8:9] op_sel_hi:[1,0]
    v_pk_mul_f32 v[18:19], v[18:19], v[46:47] op_sel_hi:[1,0]
    v_pk_mul_f32 v[64:65], v[20:21], v[18:19] op_sel:[0,0] op_sel_hi:[0,1]
    v_pk_mul_f32 v[56:57], v[48:49], v[48:49] op_sel:[0,0] op_sel_hi:[0,1]
    v_pk_mul_f32 v[54:55], v[52:53], v[52:53] op_sel:[0,0] op_sel_hi:[0,1]
    v_pk_mul_f32 v[98:99], v[96:97], v[52:53] op_sel:[0,0] op_sel_hi:[0,1]
    v_pk_fma_f32 v[64:65], v[20:21], v[18:19], v[64:65] op_sel:[1,1,0] op_sel_hi:[1,0,1] neg_lo:[1,0,0]
    v_pk_fma_f32 v[56:57], v[48:49], v[48:49], v[56:57] op_sel:[1,1,0] op_sel_hi:[1,0,1] neg_lo:[1,0,0]
    v_pk_fma_f32 v[54:55], v[52:53], v[52:53], v[54:55] op_sel:[1,1,0] op_sel_hi:[1,0,1] neg_lo:[1,0,0]
    v_pk_fma_f32 v[98:99], v[96:97], v[52:53], v[98:99] op_sel:[1,1,0] op_sel_hi:[1,0,1] neg_lo:[1,0,0]
    v_pk_mul_f32 v[66:67], v[64:65], v[48:49] op_sel:[0,0] op_sel_hi:[0,1]
    v_pk_mul_f32 v[68:69], v[64:65], v[56:57] op_sel:[0,0] op_sel_hi:[0,1]
    v_pk_mul_f32 v[50:51], v[56:57], v[56:57] op_sel:[0,0] op_sel_hi:[0,1]
    v_pk_mul_f32 v[100:101], v[96:97], v[54:55] op_sel:[0,0] op_sel_hi:[0,1]
    v_pk_mul_f32 v[102:103], v[98:99], v[54:55] op_sel:[0,0] op_sel_hi:[0,1]
    v_pk_fma_f32 v[66:67], v[64:65], v[48:49], v[66:67] op_sel:[1,1,0] op_sel_hi:[1,0,1] neg_lo:[1,0,0]
    v_pk_fma_f32 v[68:69], v[64:65], v[56:57], v[68:69] op_sel:[1,1,0] op_sel_hi:[1,0,1] neg_lo:[1,0,0]
    v_pk_fma_f32 v[50:51], v[56:57], v[56:57], v[50:51] op_sel:[1,1,0] op_sel_hi:[1,0,1] neg_lo:[1,0,0]
    v_pk_fma_f32 v[100:101], v[96:97], v[54:55], v[100:101] op_sel:[1,1,0] op_sel_hi:[1,0,1] neg_lo:[1,0,0]
    v_pk_fma_f32 v[102:103], v[98:99], v[54:55], v[102:103] op_sel:[1,1,0] op_sel_hi:[1,0,1] neg_lo:[1,0,0]
    v_pk_mul_f32 v[70:71], v[66:67], v[56:57] op_sel:[0,0] op_sel_hi:[0,1]
    v_pk_mul_f32 v[104:105], v[100:101], v[54:55] op_sel:[0,0] op_sel_hi:[0,1]
    v_pk_mul_f32 v[106:107], v[102:103], v[54:55] op_sel:[0,0] op_sel_hi:[0,1]
    v_pk_fma_f32 v[70:71], v[66:67], v[56:57], v[70:71] op_sel:[1,1,0] op_sel_hi:[1,0,1] neg_lo:[1,0,0]
    v_pk_fma_f32 v[104:105], v[100:101], v[54:55], v[104:105] op_sel:[1,1,0] op_sel_hi:[1,0,1] neg_lo:[1,0,0]
    v_pk_fma_f32 v[106:107], v[102:103], v[54:55], v[106:107] op_sel:[1,1,0] op_sel_hi:[1,0,1] neg_lo:[1,0,0]
    v_cvt_pk_bf16_f32 v4, v96, v97
    v_cvt_pk_bf16_f32 v5, v98, v99
    v_cvt_pk_bf16_f32 v6, v100, v101
    v_cvt_pk_bf16_f32 v7, v102, v103
    ds_write2_b32 v24, v4, v5 offset0:192 offset1:196
    ds_write2_b32 v24, v6, v7 offset0:200 offset1:204
    v_pk_mul_f32 v[72:73], v[64:65], v[50:51] op_sel:[0,0] op_sel_hi:[0,1]
    v_pk_mul_f32 v[74:75], v[66:67], v[50:51] op_sel:[0,0] op_sel_hi:[0,1]
    v_pk_mul_f32 v[76:77], v[68:69], v[50:51] op_sel:[0,0] op_sel_hi:[0,1]
    v_pk_mul_f32 v[78:79], v[70:71], v[50:51] op_sel:[0,0] op_sel_hi:[0,1]
    v_pk_mul_f32 v[108:109], v[104:105], v[54:55] op_sel:[0,0] op_sel_hi:[0,1]
    v_pk_mul_f32 v[110:111], v[106:107], v[54:55] op_sel:[0,0] op_sel_hi:[0,1]
    v_pk_fma_f32 v[72:73], v[64:65], v[50:51], v[72:73] op_sel:[1,1,0] op_sel_hi:[1,0,1] neg_lo:[1,0,0]
    v_pk_fma_f32 v[74:75], v[66:67], v[50:51], v[74:75] op_sel:[1,1,0] op_sel_hi:[1,0,1] neg_lo:[1,0,0]
    v_pk_fma_f32 v[76:77], v[68:69], v[50:51], v[76:77] op_sel:[1,1,0] op_sel_hi:[1,0,1] neg_lo:[1,0,0]
    v_pk_fma_f32 v[78:79], v[70:71], v[50:51], v[78:79] op_sel:[1,1,0] op_sel_hi:[1,0,1] neg_lo:[1,0,0]
    v_pk_fma_f32 v[108:109], v[104:105], v[54:55], v[108:109] op_sel:[1,1,0] op_sel_hi:[1,0,1] neg_lo:[1,0,0]
    v_pk_fma_f32 v[110:111], v[106:107], v[54:55], v[110:111] op_sel:[1,1,0] op_sel_hi:[1,0,1] neg_lo:[1,0,0]
    v_cvt_pk_bf16_f32 v8, v64, -v65
    v_cvt_pk_bf16_f32 v9, v66, -v67
    v_cvt_pk_bf16_f32 v10, v68, -v69
    v_cvt_pk_bf16_f32 v11, v70, -v71
    ds_write2_b32 v24, v8, v9 offset0:0 offset1:4
    ds_write2_b32 v24, v10, v11 offset0:8 offset1:12
    v_pk_mul_f32 v[80:81], v[72:73], v[50:51] op_sel:[0,0] op_sel_hi:[0,1]
    v_pk_mul_f32 v[82:83], v[74:75], v[50:51] op_sel:[0,0] op_sel_hi:[0,1]
    v_pk_mul_f32 v[84:85], v[76:77], v[50:51] op_sel:[0,0] op_sel_hi:[0,1]
    v_pk_mul_f32 v[86:87], v[78:79], v[50:51] op_sel:[0,0] op_sel_hi:[0,1]
    v_pk_mul_f32 v[112:113], v[108:109], v[54:55] op_sel:[0,0] op_sel_hi:[0,1]
    v_pk_fma_f32 v[80:81], v[72:73], v[50:51], v[80:81] op_sel:[1,1,0] op_sel_hi:[1,0,1] neg_lo:[1,0,0]
    v_pk_fma_f32 v[82:83], v[74:75], v[50:51], v[82:83] op_sel:[1,1,0] op_sel_hi:[1,0,1] neg_lo:[1,0,0]
    v_pk_fma_f32 v[84:85], v[76:77], v[50:51], v[84:85] op_sel:[1,1,0] op_sel_hi:[1,0,1] neg_lo:[1,0,0]
    v_pk_fma_f32 v[86:87], v[78:79], v[50:51], v[86:87] op_sel:[1,1,0] op_sel_hi:[1,0,1] neg_lo:[1,0,0]
    v_pk_fma_f32 v[112:113], v[108:109], v[54:55], v[112:113] op_sel:[1,1,0] op_sel_hi:[1,0,1] neg_lo:[1,0,0]
    v_cvt_pk_bf16_f32 v4, v72, -v73
    v_cvt_pk_bf16_f32 v5, v74, -v75
    v_cvt_pk_bf16_f32 v6, v76, -v77
    v_cvt_pk_bf16_f32 v7, v78, -v79
    ds_write2_b32 v24, v4, v5 offset0:16 offset1:20
    ds_write2_b32 v24, v6, v7 offset0:24 offset1:28
    v_pk_mul_f32 v[88:89], v[80:81], v[50:51] op_sel:[0,0] op_sel_hi:[0,1]
    v_pk_mul_f32 v[90:91], v[82:83], v[50:51] op_sel:[0,0] op_sel_hi:[0,1]
    v_pk_mul_f32 v[92:93], v[84:85], v[50:51] op_sel:[0,0] op_sel_hi:[0,1]
    v_pk_mul_f32 v[94:95], v[86:87], v[50:51] op_sel:[0,0] op_sel_hi:[0,1]
    v_pk_fma_f32 v[88:89], v[80:81], v[50:51], v[88:89] op_sel:[1,1,0] op_sel_hi:[1,0,1] neg_lo:[1,0,0]
    v_pk_fma_f32 v[90:91], v[82:83], v[50:51], v[90:91] op_sel:[1,1,0] op_sel_hi:[1,0,1] neg_lo:[1,0,0]
    v_pk_fma_f32 v[92:93], v[84:85], v[50:51], v[92:93] op_sel:[1,1,0] op_sel_hi:[1,0,1] neg_lo:[1,0,0]
    v_pk_fma_f32 v[94:95], v[86:87], v[50:51], v[94:95] op_sel:[1,1,0] op_sel_hi:[1,0,1] neg_lo:[1,0,0]
    v_cvt_pk_bf16_f32 v8, v80, -v81
    v_cvt_pk_bf16_f32 v9, v82, -v83
    v_cvt_pk_bf16_f32 v10, v84, -v85
    v_cvt_pk_bf16_f32 v11, v86, -v87
    ds_write2_b32 v24, v8, v9 offset0:32 offset1:36
    ds_write2_b32 v24, v10, v11 offset0:40 offset1:44
    v_cvt_pk_bf16_f32 v4, v88, -v89
    v_cvt_pk_bf16_f32 v5, v90, -v91
    v_cvt_pk_bf16_f32 v6, v92, -v93
    v_cvt_pk_bf16_f32 v7, v94, -v95
    ds_write2_b32 v24, v4, v5 offset0:48 offset1:52
    ds_write2_b32 v24, v6, v7 offset0:56 offset1:60
    v_cvt_pk_bf16_f32 v8, v104, v105
    v_cvt_pk_bf16_f32 v9, v106, v107
    v_cvt_pk_bf16_f32 v10, v108, v109
    v_cvt_pk_bf16_f32 v11, v110, v111
    v_cvt_pk_bf16_f32 v4, v112, v113
    ds_write2_b32 v24, v8, v9 offset0:208 offset1:212
    ds_write2_b32 v24, v10, v11 offset0:216 offset1:220
    ds_write_b32 v24, v4 offset:896
    s_branch L_kg2
L_kg1:
    v_mul_f32 v4, 0x3f800000, v44
    v_mul_f32 v5, 0x3f800000, v45
    v_mul_f32 v6, 0x43000000, v44
    v_mul_f32 v7, 0x43000000, v45
    v_fract_f32 v5, v5
    v_fract_f32 v7, v7
    v_exp_f32 v4, v4
    v_cos_f32 v50, v5
    v_sin_f32 v51, v5
    v_exp_f32 v6, v6
    v_cos_f32 v66, v7
    v_sin_f32 v67, v7
    v_pk_mul_f32 v[50:51], v[50:51], v[4:5] op_sel_hi:[1,0]
    v_pk_mul_f32 v[66:67], v[66:67], v[6:7] op_sel_hi:[1,0]
    v_mov_b32 v48, 0x3f80
    v_pk_mul_f32 v[52:53], v[50:51], v[50:51] op_sel:[0,0] op_sel_hi:[0,1]
    v_pk_mul_f32 v[68:69], v[66:67], v[66:67] op_sel:[0,0] op_sel_hi:[0,1]
    v_pk_fma_f32 v[52:53], v[50:51], v[50:51], v[52:53] op_sel:[1,1,0] op_sel_hi:[1,0,1] neg_lo:[1,0,0]
    v_pk_fma_f32 v[68:69], v[66:67], v[66:67], v[68:69] op_sel:[1,1,0] op_sel_hi:[1,0,1] neg_lo:[1,0,0]
    v_pk_mul_f32 v[54:55], v[52:53], v[50:51] op_sel:[0,0] op_sel_hi:[0,1]
    v_pk_mul_f32 v[56:57], v[52:53], v[52:53] op_sel:[0,0] op_sel_hi:[0,1]
    v_pk_mul_f32 v[70:71], v[68:69], v[66:67] op_sel:[0,0] op_sel_hi:[0,1]
    v_pk_mul_f32 v[72:73], v[68:69], v[68:69] op_sel:[0,0] op_sel_hi:[0,1]
    v_pk_fma_f32 v[54:55], v[52:53], v[50:51], v[54:55] op_sel:[1,1,0] op_sel_hi:[1,0,1] neg_lo:[1,0,0]
    v_pk_fma_f32 v[56:57], v[52:53], v[52:53], v[56:57] op_sel:[1,1,0] op_sel_hi:[1,0,1] neg_lo:[1,0,0]
    v_pk_fma_f32 v[70:71], v[68:69], v[66:67], v[70:71] op_sel:[1,1,0] op_sel_hi:[1,0,1] neg_lo:[1,0,0]
    v_pk_fma_f32 v[72:73], v[68:69], v[68:69], v[72:73] op_sel:[1,1,0] op_sel_hi:[1,0,1] neg_lo:[1,0,0]
    v_pk_mul_f32 v[58:59], v[56:57], v[50:51] op_sel:[0,0] op_sel_hi:[0,1]
    v_pk_mul_f32 v[60:61], v[56:57], v[52:53] op_sel:[0,0] op_sel_hi:[0,1]
    v_pk_mul_f32 v[62:63], v[56:57], v[54:55] op_sel:[0,0] op_sel_hi:[0,1]
    v_pk_mul_f32 v[74:75], v[72:73], v[66:67] op_sel:[0,0] op_sel_hi:[0,1]
    v_pk_mul_f32 v[76:77], v[72:73], v[68:69] op_sel:[0,0] op_sel_hi:[0,1]
    v_pk_mul_f32 v[78:79], v[72:73], v[70:71] op_sel:[0,0] op_sel_hi:[0,1]
    v_pk_fma_f32 v[58:59], v[56:57], v[50:51], v[58:59] op_sel:[1,1,0] op_sel_hi:[1,0,1] neg_lo:[1,0,0]
    v_pk_fma_f32 v[60:61], v[56:57], v[52:53], v[60:61] op_sel:[1,1,0] op_sel_hi:[1,0,1] neg_lo:[1,0,0]
    v_pk_fma_f32 v[62:63], v[56:57], v[54:55], v[62:63] op_sel:[1,1,0] op_sel_hi:[1,0,1] neg_lo:[1,0,0]
    v_pk_fma_f32 v[74:75], v[72:73], v[66:67], v[74:75] op_sel:[1,1,0] op_sel_hi:[1,0,1] neg_lo:[1,0,0]
    v_pk_fma_f32 v[76:77], v[72:73], v[68:69], v[76:77] op_sel:[1,1,0] op_sel_hi:[1,0,1] neg_lo:[1,0,0]
    v_pk_fma_f32 v[78:79], v[72:73], v[70:71], v[78:79] op_sel:[1,1,0] op_sel_hi:[1,0,1] neg_lo:[1,0,0]
    v_cvt_pk_bf16_f32 v5, v50, v51
    v_cvt_pk_bf16_f32 v6, v52, v53
    v_cvt_pk_bf16_f32 v7, v54, v55
    v_cvt_pk_bf16_f32 v8, v56, v57
    v_cvt_pk_bf16_f32 v9, v58, v59
    v_cvt_pk_bf16_f32 v10, v60, v61
    v_cvt_pk_bf16_f32 v11, v62, v63
    ds_write2_b32 v24, v48, v5 offset0:64 offset1:68
    ds_write2_b32 v24, v6, v7 offset0:72 offset1:76
    ds_write2_b32 v24, v8, v9 offset0:80 offset1:84
    ds_write2_b32 v24, v10, v11 offset0:88 offset1:92
    v_pk_mul_f32 v[82:83], v[50:51], v[66:67] op_sel:[0,0] op_sel_hi:[0,1]
    v_pk_mul_f32 v[84:85], v[52:53], v[66:67] op_sel:[0,0] op_sel_hi:[0,1]
    v_pk_mul_f32 v[86:87], v[54:55], v[66:67] op_sel:[0,0] op_sel_hi:[0,1]
    v_pk_mul_f32 v[88:89], v[56:57], v[66:67] op_sel:[0,0] op_sel_hi:[0,1]
    v_pk_mul_f32 v[90:91], v[58:59], v[66:67] op_sel:[0,0] op_sel_hi:[0,1]
    v_pk_mul_f32 v[92:93], v[60:61], v[66:67] op_sel:[0,0] op_sel_hi:[0,1]
    v_pk_mul_f32 v[94:95], v[62:63], v[66:67] op_sel:[0,0] op_sel_hi:[0,1]
    v_pk_fma_f32 v[82:83], v[50:51], v[66:67], v[82:83] op_sel:[1,1,0] op_sel_hi:[1,0,1] neg_lo:[1,0,0]
    v_pk_fma_f32 v[84:85], v[52:53], v[66:67], v[84:85] op_sel:[1,1,0] op_sel_hi:[1,0,1] neg_lo:[1,0,0]
    v_pk_fma_f32 v[86:87], v[54:55], v[66:67], v[86:87] op_sel:[1,1,0] op_sel_hi:[1,0,1] neg_lo:[1,0,0]
    v_pk_fma_f32 v[88:89], v[56:57], v[66:67], v[88:89] op_sel:[1,1,0] op_sel_hi:[1,0,1] neg_lo:[1,0,0]
    v_pk_fma_f32 v[90:91], v[58:59], v[66:67], v[90:91] op_sel:[1,1,0] op_sel_hi:[1,0,1] neg_lo:[1,0,0]
    v_pk_fma_f32 v[92:93], v[60:61], v[66:67], v[92:93] op_sel:[1,1,0] op_sel_hi:[1,0,1] neg_lo:[1,0,0]
    v_pk_fma_f32 v[94:95], v[62:63], v[66:67], v[94:95] op_sel:[1,1,0] op_sel_hi:[1,0,1] neg_lo:[1,0,0]
    v_cvt_pk_bf16_f32 v4, v66, v67
    v_cvt_pk_bf16_f32 v5, v68, v69
    v_cvt_pk_bf16_f32 v6, v70, v71
    v_cvt_pk_bf16_f32 v7, v72, v73
    v_cvt_pk_bf16_f32 v8, v74, v75
    v_cvt_pk_bf16_f32 v9, v76, v77
    v_cvt_pk_bf16_f32 v10, v78, v79
    ds_write2_b32 v24, v4, v5 offset0:96 offset1:128
    ds_write2_b32 v24, v6, v7 offset0:144 offset1:160
    ds_write2_b32 v24, v8, v9 offset0:168 offset1:176
    v_pk_mul_f32 v[96:97], v[52:53], v[68:69] op_sel:[0,0] op_sel_hi:[0,1]
    v_pk_mul_f32 v[98:99], v[56:57], v[68:69] op_sel:[0,0] op_sel_hi:[0,1]
    v_pk_mul_f32 v[100:101], v[60:61], v[68:69] op_sel:[0,0] op_sel_hi:[0,1]
    v_pk_mul_f32 v[102:103], v[52:53], v[70:71] op_sel:[0,0] op_sel_hi:[0,1]
    v_pk_mul_f32 v[104:105], v[56:57], v[70:71] op_sel:[0,0] op_sel_hi:[0,1]
    v_pk_mul_f32 v[106:107], v[60:61], v[70:71] op_sel:[0,0] op_sel_hi:[0,1]
    v_pk_fma_f32 v[96:97], v[52:53], v[68:69], v[96:97] op_sel:[1,1,0] op_sel_hi:[1,0,1] neg_lo:[1,0,0]
    v_pk_fma_f32 v[98:99], v[56:57], v[68:69], v[98:99] op_sel:[1,1,0] op_sel_hi:[1,0,1] neg_lo:[1,0,0]
    v_pk_fma_f32 v[100:101], v[60:61], v[68:69], v[100:101] op_sel:[1,1,0] op_sel_hi:[1,0,1] neg_lo:[1,0,0]
    v_pk_fma_f32 v[102:103], v[52:53], v[70:71], v[102:103] op_sel:[1,1,0] op_sel_hi:[1,0,1] neg_lo:[1,0,0]
    v_pk_fma_f32 v[104:105], v[56:57], v[70:71], v[104:105] op_sel:[1,1,0] op_sel_hi:[1,0,1] neg_lo:[1,0,0]
    v_pk_fma_f32 v[106:107], v[60:61], v[70:71], v[106:107] op_sel:[1,1,0] op_sel_hi:[1,0,1] neg_lo:[1,0,0]
    v_cvt_pk_bf16_f32 v11, v82, v83
    v_cvt_pk_bf16_f32 v4, v84, v85
    v_cvt_pk_bf16_f32 v5, v86, v87
    v_cvt_pk_bf16_f32 v6, v88, v89
    v_cvt_pk_bf16_f32 v7, v90, v91
    v_cvt_pk_bf16_f32 v8, v92, v93
    v_cvt_pk_bf16_f32 v9, v94, v95
    ds_write2_b32 v24, v10, v11 offset0:184 offset1:100
    ds_write2_b32 v24, v4, v5 offset0:104 offset1:108
    ds_write2_b32 v24, v6, v7 offset0:112 offset1:116
    ds_write2_b32 v24, v8, v9 offset0:120 offset1:124
    v_pk_mul_f32 v[80:81], v[56:57], v[72:73] op_sel:[0,0] op_sel_hi:[0,1]
    v_pk_mul_f32 v[82:83], v[56:57], v[74:75] op_sel:[0,0] op_sel_hi:[0,1]
    v_pk_mul_f32 v[84:85], v[56:57], v[76:77] op_sel:[0,0] op_sel_hi:[0,1]
    v_pk_mul_f32 v[86:87], v[56:57], v[78:79] op_sel:[0,0] op_sel_hi:[0,1]
    v_pk_fma_f32 v[80:81], v[56:57], v[72:73], v[80:81] op_sel:[1,1,0] op_sel_hi:[1,0,1] neg_lo:[1,0,0]
    v_pk_fma_f32 v[82:83], v[56:57], v[74:75], v[82:83] op_sel:[1,1,0] op_sel_hi:[1,0,1] neg_lo:[1,0,0]
    v_pk_fma_f32 v[84:85], v[56:57], v[76:77], v[84:85] op_sel:[1,1,0] op_sel_hi:[1,0,1] neg_lo:[1,0,0]
    v_pk_fma_f32 v[86:87], v[56:57], v[78:79], v[86:87] op_sel:[1,1,0] op_sel_hi:[1,0,1] neg_lo:[1,0,0]
    v_cvt_pk_bf16_f32 v10, v96, v97
    v_cvt_pk_bf16_f32 v11, v98, v99
    v_cvt_pk_bf16_f32 v4, v100, v101
    v_cvt_pk_bf16_f32 v5, v102, v103
    v_cvt_pk_bf16_f32 v6, v104, v105
    v_cvt_pk_bf16_f32 v7, v106, v107
    ds_write2_b32 v24, v10, v11 offset0:132 offset1:136
    ds_write2_b32 v24, v4, v5 offset0:140 offset1:148
    ds_write2_b32 v24, v6, v7 offset0:152 offset1:156
    v_cvt_pk_bf16_f32 v8, v80, v81
    v_cvt_pk_bf16_f32 v9, v82, v83
    v_cvt_pk_bf16_f32 v10, v84, v85
    v_cvt_pk_bf16_f32 v11, v86, v87
    ds_write2_b32 v24, v8, v9 offset0:164 offset1:172
    ds_write2_b32 v24, v10, v11 offset0:180 offset1:188
L_kg2:
    s_waitcnt lgkmcnt(0)
    s_barrier
    v_lshl_add_u64 v[12:13], s[36:37], 0, 1
    s_cmp_lt_u32 s24, 4
    s_cbranch_scc1 L_kg2c
    s_lshl_b32 s3, s24, 7
    s_add_u32 s39, s39, s3
    s_sub_u32 s39, s39, 512
    v_mov_b32 v16, 0
    v_mov_b32 v17, 0
    s_mov_b64 exec, 0xffff
    buffer_atomic_or_x2 v[16:17], v22, s[8:11], s39 offen sc0 sc1
    s_mov_b64 exec, -1
    s_lshl_b32 s3, s24, 11
    s_add_u32 s47, s45, s3
    s_sub_u32 s47, s47, 8192
L_kg2c:
    s_and_b32 s3, s24, 5
    s_cmp_eq_u32 s3, 5
    s_cbranch_scc1 L_kg3
    ds_read_b128 v[48:51], v26 offset:256
    ds_read_b128 v[52:55], v25 offset:0
    ds_read_b128 v[56:59], v26 offset:1168
    ds_read_b128 v[60:63], v25 offset:912
    ds_read_b128 v[64:67], v26 offset:2080
    ds_read_b128 v[68:71], v25 offset:1824
    ds_read_b128 v[72:75], v26 offset:2992
    ds_read_b128 v[76:79], v25 offset:2736
    ds_read_b128 v[80:83], v26 offset:3904
    ds_read_b128 v[84:87], v25 offset:3648
    ds_read_b128 v[88:91], v26 offset:4816
    ds_read_b128 v[92:95], v25 offset:4560
    ds_read_b128 v[96:99], v26 offset:5728
    ds_read_b128 v[100:103], v25 offset:5472
    ds_read_b128 v[104:107], v26 offset:6640
    ds_read_b128 v[108:111], v25 offset:6384
    s_add_u32 s38, s28, 576
    s_cmp_eq_u32 s29, 1
    s_cbranch_scc1 L_ka1
    s_cmp_eq_u32 s29, 0
    s_cbranch_scc1 L_ka0
    v_lshlrev_b32 v4, 2, v2
    v_lshl_add_u32 v4, v3, 8, v4
    v_add_u32 v4, 2048, v4
    v_mov_b32 v5, 64
    v_mov_b32 v6, 128
    s_branch L_ka2
L_ka0:
    v_lshrrev_b32 v5, 1, v3
    v_lshlrev_b32 v4, 5, v2
    v_lshl_add_u32 v4, v5, 9, v4
    v_and_b32 v5, 1, v3
    v_lshl_add_u32 v4, v5, 4, v4
    v_mov_b32 v5, 4
    v_mov_b32 v6, 8
    s_branch L_ka2
L_ka1:
    v_lshrrev_b32 v5, 1, v3
    v_sub_u32 v4, 4, v5
    v_lshlrev_b32 v4, v4, v2
    v_lshl_add_u32 v4, v3, 8, v4
    v_add_u32 v4, 1024, v4
    v_mul_u32_u24 v6, 120, v5
    v_add_u32 v6, 8, v6
    v_mov_b32 v5, 4
L_ka2:
    v_add_u32 v4, s38, v4
    v_add_u32 v6, v4, v6
    v_add_u32 v7, v6, v5
    v_add_u32 v5, v4, v5
    s_waitcnt lgkmcnt(14)
    v_mfma_f32_16x16x32_bf16 v[112:115], v[48:51], v[52:55], 0
    s_waitcnt lgkmcnt(12)
    v_mfma_f32_16x16x32_bf16 v[112:115], v[56:59], v[60:63], v[112:115]
    s_waitcnt lgkmcnt(10)
    v_mfma_f32_16x16x32_bf16 v[112:115], v[64:67], v[68:71], v[112:115]
    s_waitcnt lgkmcnt(8)
    v_mfma_f32_16x16x32_bf16 v[112:115], v[72:75], v[76:79], v[112:115]
    s_waitcnt lgkmcnt(6)
    v_mfma_f32_16x16x32_bf16 v[112:115], v[80:83], v[84:87], v[112:115]
    s_waitcnt lgkmcnt(4)
    v_mfma_f32_16x16x32_bf16 v[112:115], v[88:91], v[92:95], v[112:115]
    s_waitcnt lgkmcnt(2)
    v_mfma_f32_16x16x32_bf16 v[112:115], v[96:99], v[100:103], v[112:115]
    s_waitcnt lgkmcnt(0)
    v_mfma_f32_16x16x32_bf16 v[112:115], v[104:107], v[108:111], v[112:115]
    s_nop 7
    ds_write_b32 v4, v112
    ds_write_b32 v5, v113
    ds_write_b32 v6, v114
    ds_write_b32 v7, v115
L_kg3:
    s_waitcnt lgkmcnt(0)
    s_barrier
    s_cmp_lt_u32 s24, 4
    s_cbranch_scc1 L_kg3c
    s_waitcnt vmcnt(0)
    s_mov_b64 exec, 0xffff
    v_cmp_ne_u64 vcc, v[16:17], v[12:13]
    s_nop 0
    s_mov_b32 s33, vcc_lo
    s_cbranch_vccz L_kg3d
    v_mov_b32 v16, 0
    v_mov_b32 v17, 0
    buffer_atomic_or_x2 v[16:17], v22, s[8:11], s39 offen sc0 sc1
    s_mov_b64 exec, -1
    s_branch L_help
L_kg3d:
    s_mov_b64 exec, -1
    buffer_load_dwordx4 v[96:99], v1, s[8:11], s47 offen sc1
    buffer_load_dwordx4 v[100:103], v1, s[8:11], s47 offen offset:1024 sc1
    s_branch L_help
L_kg3c:
    ds_read_b32 v80, v32
    ds_read_b32 v81, v33
    ds_read_b32 v82, v34
    ds_read_b32 v83, v35
    ds_read_b32 v84, v36
    ds_read_b32 v85, v37
    ds_read_b32 v86, v38
    ds_read_b32 v87, v39
    ds_read_b32 v88, v40
    ds_read_b32 v89, v41
    ds_read_b32 v90, v42
    v_mov_b32 v23, s31
    v_cndmask_b32 v23, 0, v23, s[34:35]
    s_lshl_b32 s3, s26, 6
    s_add_u32 s44, s44, s3
    s_add_u32 s43, s44, 4096
    s_waitcnt lgkmcnt(0)
    v_add_f32 v87, v87, v23
    v_cvt_pk_bf16_f32 v48, v80, v81
    v_cvt_pk_bf16_f32 v49, v82, v83
    v_cvt_pk_bf16_f32 v50, v84, v85
    v_cvt_pk_bf16_f32 v51, v86, v87
    ds_write_b128 v31, v[48:51] offset:12480
    v_cvt_pk_bf16_f32 v52, v81, v82
    v_cvt_pk_bf16_f32 v53, v83, v84
    v_cvt_pk_bf16_f32 v54, v85, v86
    v_cvt_pk_bf16_f32 v55, v87, v88
    ds_write_b128 v31, v[52:55] offset:8320
    v_cvt_pk_bf16_f32 v56, v82, v83
    v_cvt_pk_bf16_f32 v57, v84, v85
    v_cvt_pk_bf16_f32 v58, v86, v87
    v_cvt_pk_bf16_f32 v59, v88, v89
    ds_write_b128 v31, v[56:59] offset:4160
    v_cvt_pk_bf16_f32 v60, v83, v84
    v_cvt_pk_bf16_f32 v61, v85, v86
    v_cvt_pk_bf16_f32 v62, v87, v88
    v_cvt_pk_bf16_f32 v63, v89, v90
    ds_write_b128 v31, v[60:63] offset:0
    s_bitcmp1_b32 s24, 0
    s_cbranch_scc1 L_cv1
    s_waitcnt lgkmcnt(0)
    s_barrier
    s_setprio 1
    ds_read_b128 v[48:51], v28 offset:2048
    ds_read_b128 v[52:55], v28 offset:1536
    ds_read_b128 v[56:59], v28 offset:1024
    ds_read_b128 v[60:63], v28 offset:512
    ds_read_b128 v[64:67], v28 offset:0
    ds_read_b128 v[68:71], v28 offset:448
    s_waitcnt lgkmcnt(0)
    s_barrier
    ds_read_b128 v[72:75], v29 offset:4032
    ds_read_b128 v[76:79], v29 offset:3520
    ds_read_b128 v[80:83], v29 offset:3008
    ds_read_b128 v[84:87], v29 offset:448
    ds_read_b128 v[88:91], v29 offset:2496
    ds_read_b128 v[92:95], v29 offset:1984
    ds_read_b128 v[96:99], v29 offset:1472
    ds_read_b128 v[100:103], v29 offset:960
    s_waitcnt lgkmcnt(7)
    v_mfma_f32_16x16x32_bf16 v[32:35], v[48:51], v[72:75], 0
    ds_read_b128 v[104:107], v29 offset:2432
    s_waitcnt lgkmcnt(7)
    v_mfma_f32_16x16x32_bf16 v[36:39], v[48:51], v[76:79], 0
    ds_read_b128 v[72:75], v29 offset:1920
    s_waitcnt lgkmcnt(7)
    v_mfma_f32_16x16x32_bf16 v[40:43], v[48:51], v[80:83], 0
    s_waitcnt lgkmcnt(6)
    v_mfma_f32_16x16x32_bf16 v[44:47], v[48:51], v[84:87], 0
    ds_read_b128 v[48:51], v29 offset:1408
    v_mfma_f32_16x16x32_bf16 v[32:35], v[52:55], v[76:79], v[32:35]
    ds_read_b128 v[84:87], v28 offset:960
    v_mfma_f32_16x16x32_bf16 v[36:39], v[52:55], v[80:83], v[36:39]
    ds_read_b128 v[76:79], v29 offset:2944
    s_waitcnt lgkmcnt(8)
    v_mfma_f32_16x16x32_bf16 v[40:43], v[52:55], v[88:91], v[40:43]
    ds_read_b128 v[52:55], v28 offset:1472
    v_mfma_f32_16x16x32_bf16 v[32:35], v[56:59], v[80:83], v[32:35]
    ds_read_b128 v[80:83], v29 offset:3456
    v_mfma_f32_16x16x32_bf16 v[36:39], v[56:59], v[88:91], v[36:39]
    s_waitcnt lgkmcnt(9)
    v_mfma_f32_16x16x32_bf16 v[40:43], v[56:59], v[92:95], v[40:43]
    ds_read_b128 v[56:59], v28 offset:1984
    v_mfma_f32_16x16x32_bf16 v[32:35], v[60:63], v[88:91], v[32:35]
    ds_read_b128 v[88:91], v29 offset:3968
    v_mfma_f32_16x16x32_bf16 v[36:39], v[60:63], v[92:95], v[36:39]
    s_waitcnt lgkmcnt(10)
    v_mfma_f32_16x16x32_bf16 v[40:43], v[60:63], v[96:99], v[40:43]
    ds_read_b128 v[60:63], v29 offset:384
    v_mfma_f32_16x16x32_bf16 v[32:35], v[64:67], v[92:95], v[32:35]
    ds_read_b128 v[92:95], v28 offset:1920
    v_mfma_f32_16x16x32_bf16 v[36:39], v[64:67], v[96:99], v[36:39]
    ds_read_b128 v[96:99], v29 offset:3904
    s_waitcnt lgkmcnt(10)
    v_mfma_f32_16x16x32_bf16 v[40:43], v[64:67], v[100:103], v[40:43]
    ds_read_b128 v[64:67], v29 offset:3392
    v_mfma_f32_16x16x32_bf16 v[32:35], v[68:71], v[104:107], v[32:35]
    ds_read_b128 v[100:103], v29 offset:2880
    v_mfma_f32_16x16x32_bf16 v[36:39], v[68:71], v[72:75], v[36:39]
    s_waitcnt lgkmcnt(9)
    v_mfma_f32_16x16x32_bf16 v[40:43], v[68:71], v[48:51], v[40:43]
    ds_read_b128 v[68:71], v29 offset:320
    v_mfma_f32_16x16x32_bf16 v[32:35], v[84:87], v[76:79], v[32:35]
    ds_read_b128 v[48:51], v28 offset:1408
    v_mfma_f32_16x16x32_bf16 v[36:39], v[84:87], v[104:107], v[36:39]
    s_waitcnt lgkmcnt(9)
    v_mfma_f32_16x16x32_bf16 v[40:43], v[84:87], v[72:75], v[40:43]
    ds_read_b128 v[84:87], v29 offset:2368
    v_mfma_f32_16x16x32_bf16 v[32:35], v[52:55], v[80:83], v[32:35]
    ds_read_b128 v[72:75], v28 offset:896
    v_mfma_f32_16x16x32_bf16 v[36:39], v[52:55], v[76:79], v[36:39]
    s_waitcnt lgkmcnt(9)
    v_mfma_f32_16x16x32_bf16 v[40:43], v[52:55], v[104:107], v[40:43]
    ds_read_b128 v[52:55], v29 offset:1856
    v_mfma_f32_16x16x32_bf16 v[32:35], v[56:59], v[88:91], v[32:35]
    ds_read_b128 v[104:107], v28 offset:384
    v_mfma_f32_16x16x32_bf16 v[36:39], v[56:59], v[80:83], v[36:39]
    ds_read_b128 v[88:91], v29 offset:1344
    s_waitcnt lgkmcnt(9)
    v_mfma_f32_16x16x32_bf16 v[40:43], v[56:59], v[76:79], v[40:43]
    ds_read_b128 v[80:83], v28 offset:320
    v_mfma_f32_16x16x32_bf16 v[44:47], v[56:59], v[60:63], v[44:47]
    ds_read_b128 v[76:79], v29 offset:2304
    v_mfma_f32_16x16x32_bf16 v[32:35], v[92:95], v[96:99], v[32:35]
    ds_read_b128 v[56:59], v29 offset:1792
    s_waitcnt lgkmcnt(9)
    v_mfma_f32_16x16x32_bf16 v[36:39], v[92:95], v[64:67], v[36:39]
    ds_read_b128 v[60:63], v29 offset:1280
    v_mfma_f32_16x16x32_bf16 v[40:43], v[92:95], v[100:103], v[40:43]
    ds_read_b128 v[96:99], v28 offset:832
    v_mfma_f32_16x16x32_bf16 v[44:47], v[92:95], v[68:71], v[44:47]
    ds_read_b128 v[92:95], v29 offset:2816
    s_waitcnt lgkmcnt(10)
    v_mfma_f32_16x16x32_bf16 v[32:35], v[48:51], v[64:67], v[32:35]
    ds_read_b128 v[68:71], v28 offset:1344
    v_mfma_f32_16x16x32_bf16 v[36:39], v[48:51], v[100:103], v[36:39]
    ds_read_b128 v[64:67], v29 offset:3328
    v_mfma_f32_16x16x32_bf16 v[40:43], v[48:51], v[84:87], v[40:43]
    ds_read_b128 v[48:51], v28 offset:1856
    s_waitcnt lgkmcnt(11)
    v_mfma_f32_16x16x32_bf16 v[32:35], v[72:75], v[100:103], v[32:35]
    ds_read_b128 v[100:103], v29 offset:3840
    v_mfma_f32_16x16x32_bf16 v[36:39], v[72:75], v[84:87], v[36:39]
    v_mfma_f32_16x16x32_bf16 v[40:43], v[72:75], v[52:55], v[40:43]
    ds_read_b128 v[72:75], v29 offset:256
    s_waitcnt lgkmcnt(11)
    v_mfma_f32_16x16x32_bf16 v[32:35], v[104:107], v[84:87], v[32:35]
    ds_read_b128 v[84:87], v28 offset:1792
    v_mfma_f32_16x16x32_bf16 v[36:39], v[104:107], v[52:55], v[36:39]
    ds_read_b128 v[52:55], v29 offset:3776
    v_mfma_f32_16x16x32_bf16 v[40:43], v[104:107], v[88:91], v[40:43]
    ds_read_b128 v[104:107], v29 offset:3264
    s_waitcnt lgkmcnt(10)
    v_mfma_f32_16x16x32_bf16 v[32:35], v[80:83], v[76:79], v[32:35]
    ds_read_b128 v[88:91], v29 offset:2752
    v_mfma_f32_16x16x32_bf16 v[36:39], v[80:83], v[56:59], v[36:39]
    v_mfma_f32_16x16x32_bf16 v[40:43], v[80:83], v[60:63], v[40:43]
    ds_read_b128 v[80:83], v29 offset:192
    s_waitcnt lgkmcnt(10)
    v_mfma_f32_16x16x32_bf16 v[32:35], v[96:99], v[92:95], v[32:35]
    ds_read_b128 v[60:63], v28 offset:1280
    v_mfma_f32_16x16x32_bf16 v[36:39], v[96:99], v[76:79], v[36:39]
    v_mfma_f32_16x16x32_bf16 v[40:43], v[96:99], v[56:59], v[40:43]
    ds_read_b128 v[96:99], v29 offset:2240
    s_waitcnt lgkmcnt(10)
    v_mfma_f32_16x16x32_bf16 v[32:35], v[68:71], v[64:67], v[32:35]
    ds_read_b128 v[56:59], v28 offset:768
    v_mfma_f32_16x16x32_bf16 v[36:39], v[68:71], v[92:95], v[36:39]
    v_mfma_f32_16x16x32_bf16 v[40:43], v[68:71], v[76:79], v[40:43]
    ds_read_b128 v[68:71], v29 offset:1728
    s_waitcnt lgkmcnt(10)
    v_mfma_f32_16x16x32_bf16 v[32:35], v[48:51], v[100:103], v[32:35]
    ds_read_b128 v[76:79], v28 offset:256
    v_mfma_f32_16x16x32_bf16 v[36:39], v[48:51], v[64:67], v[36:39]
    ds_read_b128 v[100:103], v29 offset:1216
    v_mfma_f32_16x16x32_bf16 v[40:43], v[48:51], v[92:95], v[40:43]
    ds_read_b128 v[64:67], v28 offset:192
    s_waitcnt lgkmcnt(9)
    v_mfma_f32_16x16x32_bf16 v[44:47], v[48:51], v[72:75], v[44:47]
    ds_read_b128 v[92:95], v29 offset:2176
    v_mfma_f32_16x16x32_bf16 v[32:35], v[84:87], v[52:55], v[32:35]
    ds_read_b128 v[48:51], v29 offset:1664
    v_mfma_f32_16x16x32_bf16 v[36:39], v[84:87], v[104:107], v[36:39]
    ds_read_b128 v[72:75], v29 offset:1152
    s_waitcnt lgkmcnt(9)
    v_mfma_f32_16x16x32_bf16 v[40:43], v[84:87], v[88:91], v[40:43]
    ds_read_b128 v[52:55], v28 offset:704
    v_mfma_f32_16x16x32_bf16 v[44:47], v[84:87], v[80:83], v[44:47]
    ds_read_b128 v[84:87], v29 offset:2688
    v_mfma_f32_16x16x32_bf16 v[32:35], v[60:63], v[104:107], v[32:35]
    ds_read_b128 v[80:83], v28 offset:1216
    s_waitcnt lgkmcnt(10)
    v_mfma_f32_16x16x32_bf16 v[36:39], v[60:63], v[88:91], v[36:39]
    ds_read_b128 v[104:107], v29 offset:3200
    v_mfma_f32_16x16x32_bf16 v[40:43], v[60:63], v[96:99], v[40:43]
    ds_read_b128 v[60:63], v28 offset:1728
    v_mfma_f32_16x16x32_bf16 v[32:35], v[56:59], v[88:91], v[32:35]
    ds_read_b128 v[88:91], v29 offset:3712
    s_waitcnt lgkmcnt(11)
    v_mfma_f32_16x16x32_bf16 v[36:39], v[56:59], v[96:99], v[36:39]
    v_mfma_f32_16x16x32_bf16 v[40:43], v[56:59], v[68:71], v[40:43]
    ds_read_b128 v[56:59], v29 offset:128
    v_mfma_f32_16x16x32_bf16 v[32:35], v[76:79], v[96:99], v[32:35]
    ds_read_b128 v[96:99], v28 offset:1664
    s_waitcnt lgkmcnt(10)
    v_mfma_f32_16x16x32_bf16 v[36:39], v[76:79], v[68:71], v[36:39]
    ds_read_b128 v[68:71], v29 offset:3648
    v_mfma_f32_16x16x32_bf16 v[40:43], v[76:79], v[100:103], v[40:43]
    ds_read_b128 v[76:79], v29 offset:3136
    v_mfma_f32_16x16x32_bf16 v[32:35], v[64:67], v[92:95], v[32:35]
    ds_read_b128 v[100:103], v29 offset:2624
    s_waitcnt lgkmcnt(9)
    v_mfma_f32_16x16x32_bf16 v[36:39], v[64:67], v[48:51], v[36:39]
    v_mfma_f32_16x16x32_bf16 v[40:43], v[64:67], v[72:75], v[40:43]
    ds_read_b128 v[64:67], v29 offset:64
    v_mfma_f32_16x16x32_bf16 v[32:35], v[52:55], v[84:87], v[32:35]
    ds_read_b128 v[72:75], v28 offset:1152
    s_waitcnt lgkmcnt(9)
    v_mfma_f32_16x16x32_bf16 v[36:39], v[52:55], v[92:95], v[36:39]
    v_mfma_f32_16x16x32_bf16 v[40:43], v[52:55], v[48:51], v[40:43]
    ds_read_b128 v[52:55], v29 offset:2112
    v_mfma_f32_16x16x32_bf16 v[32:35], v[80:83], v[104:107], v[32:35]
    ds_read_b128 v[48:51], v28 offset:640
    s_waitcnt lgkmcnt(9)
    v_mfma_f32_16x16x32_bf16 v[36:39], v[80:83], v[84:87], v[36:39]
    v_mfma_f32_16x16x32_bf16 v[40:43], v[80:83], v[92:95], v[40:43]
    ds_read_b128 v[80:83], v29 offset:1600
    v_mfma_f32_16x16x32_bf16 v[32:35], v[60:63], v[88:91], v[32:35]
    ds_read_b128 v[92:95], v28 offset:128
    s_waitcnt lgkmcnt(10)
    v_mfma_f32_16x16x32_bf16 v[36:39], v[60:63], v[104:107], v[36:39]
    ds_read_b128 v[88:91], v29 offset:1088
    v_mfma_f32_16x16x32_bf16 v[40:43], v[60:63], v[84:87], v[40:43]
    ds_read_b128 v[104:107], v28 offset:64
    v_mfma_f32_16x16x32_bf16 v[44:47], v[60:63], v[56:59], v[44:47]
    ds_read_b128 v[84:87], v29 offset:2048
    s_waitcnt lgkmcnt(9)
    v_mfma_f32_16x16x32_bf16 v[32:35], v[96:99], v[68:71], v[32:35]
    ds_read_b128 v[60:63], v29 offset:1536
    v_mfma_f32_16x16x32_bf16 v[36:39], v[96:99], v[76:79], v[36:39]
    ds_read_b128 v[56:59], v29 offset:1024
    v_mfma_f32_16x16x32_bf16 v[40:43], v[96:99], v[100:103], v[40:43]
    ds_read_b128 v[68:71], v28 offset:576
    s_waitcnt lgkmcnt(10)
    v_mfma_f32_16x16x32_bf16 v[44:47], v[96:99], v[64:67], v[44:47]
    ds_read_b128 v[96:99], v29 offset:2560
    v_mfma_f32_16x16x32_bf16 v[32:35], v[72:75], v[76:79], v[32:35]
    ds_read_b128 v[64:67], v28 offset:1088
    v_mfma_f32_16x16x32_bf16 v[36:39], v[72:75], v[100:103], v[36:39]
    ds_read_b128 v[76:79], v29 offset:3072
    s_waitcnt lgkmcnt(11)
    v_mfma_f32_16x16x32_bf16 v[40:43], v[72:75], v[52:55], v[40:43]
    ds_read_b128 v[72:75], v28 offset:1600
    v_mfma_f32_16x16x32_bf16 v[32:35], v[48:51], v[100:103], v[32:35]
    ds_read_b128 v[100:103], v29 offset:3584
    v_mfma_f32_16x16x32_bf16 v[36:39], v[48:51], v[52:55], v[36:39]
    s_waitcnt lgkmcnt(11)
    v_mfma_f32_16x16x32_bf16 v[40:43], v[48:51], v[80:83], v[40:43]
    ds_read_b128 v[48:51], v29 offset:0
    v_mfma_f32_16x16x32_bf16 v[32:35], v[92:95], v[52:55], v[32:35]
    v_mfma_f32_16x16x32_bf16 v[36:39], v[92:95], v[80:83], v[36:39]
    s_waitcnt lgkmcnt(8)
    v_mfma_f32_16x16x32_bf16 v[40:43], v[92:95], v[88:91], v[40:43]
    s_barrier
    ds_read_b128 v[108:111], v27 offset:19712
    ds_read_b128 v[112:115], v27 offset:18688
    ds_read_b128 v[116:119], v27 offset:17664
    v_mfma_f32_16x16x32_bf16 v[32:35], v[104:107], v[84:87], v[32:35]
    v_mfma_f32_16x16x32_bf16 v[36:39], v[104:107], v[60:63], v[36:39]
    s_waitcnt lgkmcnt(8)
    v_mfma_f32_16x16x32_bf16 v[40:43], v[104:107], v[56:59], v[40:43]
    v_mfma_f32_16x16x32_bf16 v[32:35], v[68:71], v[96:99], v[32:35]
    v_mfma_f32_16x16x32_bf16 v[36:39], v[68:71], v[84:87], v[36:39]
    s_waitcnt lgkmcnt(6)
    v_mfma_f32_16x16x32_bf16 v[40:43], v[68:71], v[60:63], v[40:43]
    v_mfma_f32_16x16x32_bf16 v[32:35], v[64:67], v[76:79], v[32:35]
    v_mfma_f32_16x16x32_bf16 v[36:39], v[64:67], v[96:99], v[36:39]
    s_waitcnt lgkmcnt(4)
    v_mfma_f32_16x16x32_bf16 v[40:43], v[64:67], v[84:87], v[40:43]
    v_mfma_f32_16x16x32_bf16 v[32:35], v[72:75], v[100:103], v[32:35]
    v_mfma_f32_16x16x32_bf16 v[36:39], v[72:75], v[76:79], v[36:39]
    s_waitcnt lgkmcnt(3)
    v_mfma_f32_16x16x32_bf16 v[40:43], v[72:75], v[96:99], v[40:43]
    v_mfma_f32_16x16x32_bf16 v[44:47], v[72:75], v[48:51], v[44:47]
    s_waitcnt lgkmcnt(0)
    s_nop 2
    v_add_f32 v108, v108, v32
    v_add_f32 v109, v109, v33
    v_add_f32 v110, v110, v34
    v_add_f32 v111, v111, v35
    v_cvt_pk_bf16_f32 v4, v108, v109
    v_cvt_pk_bf16_f32 v5, v110, v111
    buffer_store_dwordx2 v[4:5], v30, s[8:11], s43 offen offset:3072 sc1
    v_add_f32 v112, v112, v36
    v_add_f32 v113, v113, v37
    v_add_f32 v114, v114, v38
    v_add_f32 v115, v115, v39
    v_cvt_pk_bf16_f32 v6, v112, v113
    v_cvt_pk_bf16_f32 v7, v114, v115
    buffer_store_dwordx2 v[6:7], v30, s[8:11], s43 offen offset:2048 sc1
    v_add_f32 v116, v116, v40
    v_add_f32 v117, v117, v41
    v_add_f32 v118, v118, v42
    v_add_f32 v119, v119, v43
    v_cvt_pk_bf16_f32 v8, v116, v117
    v_cvt_pk_bf16_f32 v9, v118, v119
    buffer_store_dwordx2 v[8:9], v30, s[8:11], s43 offen offset:1024 sc1
    v_cvt_pk_bf16_f32 v10, v44, v45
    v_cvt_pk_bf16_f32 v11, v46, v47
    buffer_store_dwordx2 v[10:11], v30, s[8:11], s44 offen offset:0 sc1
    s_endpgm
L_cv1:
    s_waitcnt lgkmcnt(0)
    s_barrier
    s_setprio 1
    ds_read_b128 v[48:51], v28 offset:2048
    ds_read_b128 v[52:55], v28 offset:1536
    ds_read_b128 v[56:59], v28 offset:1024
    ds_read_b128 v[60:63], v28 offset:512
    ds_read_b128 v[64:67], v28 offset:0
    ds_read_b128 v[68:71], v28 offset:448
    s_waitcnt lgkmcnt(0)
    s_barrier
    ds_read_b128 v[72:75], v29 offset:2496
    ds_read_b128 v[76:79], v29 offset:1984
    ds_read_b128 v[80:83], v29 offset:1472
    ds_read_b128 v[84:87], v29 offset:960
    ds_read_b128 v[88:91], v29 offset:448
    ds_read_b128 v[92:95], v29 offset:896
    ds_read_b128 v[96:99], v29 offset:384
    ds_read_b128 v[100:103], v28 offset:960
    s_waitcnt lgkmcnt(7)
    v_mfma_f32_16x16x32_bf16 v[32:35], v[48:51], v[72:75], 0
    ds_read_b128 v[104:107], v29 offset:1408
    s_waitcnt lgkmcnt(7)
    v_mfma_f32_16x16x32_bf16 v[36:39], v[48:51], v[76:79], 0
    s_waitcnt lgkmcnt(6)
    v_mfma_f32_16x16x32_bf16 v[40:43], v[48:51], v[80:83], 0
    s_waitcnt lgkmcnt(5)
    v_mfma_f32_16x16x32_bf16 v[44:47], v[48:51], v[84:87], 0
    ds_read_b128 v[72:75], v28 offset:1472
    v_mfma_f32_16x16x32_bf16 v[32:35], v[52:55], v[76:79], v[32:35]
    ds_read_b128 v[48:51], v29 offset:1920
    v_mfma_f32_16x16x32_bf16 v[36:39], v[52:55], v[80:83], v[36:39]
    s_waitcnt lgkmcnt(6)
    v_mfma_f32_16x16x32_bf16 v[40:43], v[52:55], v[84:87], v[40:43]
    v_mfma_f32_16x16x32_bf16 v[44:47], v[52:55], v[88:91], v[44:47]
    ds_read_b128 v[76:79], v28 offset:1984
    v_mfma_f32_16x16x32_bf16 v[32:35], v[56:59], v[80:83], v[32:35]
    ds_read_b128 v[52:55], v29 offset:2432
    v_mfma_f32_16x16x32_bf16 v[36:39], v[56:59], v[84:87], v[36:39]
    v_mfma_f32_16x16x32_bf16 v[40:43], v[56:59], v[88:91], v[40:43]
    v_mfma_f32_16x16x32_bf16 v[32:35], v[60:63], v[84:87], v[32:35]
    ds_read_b128 v[80:83], v28 offset:1920
    s_waitcnt lgkmcnt(8)
    v_mfma_f32_16x16x32_bf16 v[36:39], v[60:63], v[88:91], v[36:39]
    ds_read_b128 v[56:59], v29 offset:2368
    v_mfma_f32_16x16x32_bf16 v[32:35], v[64:67], v[88:91], v[32:35]
    ds_read_b128 v[84:87], v29 offset:1856
    v_mfma_f32_16x16x32_bf16 v[32:35], v[68:71], v[92:95], v[32:35]
    ds_read_b128 v[60:63], v29 offset:1344
    s_waitcnt lgkmcnt(8)
    v_mfma_f32_16x16x32_bf16 v[36:39], v[68:71], v[96:99], v[36:39]
    ds_read_b128 v[64:67], v29 offset:832
    v_mfma_f32_16x16x32_bf16 v[32:35], v[100:103], v[104:107], v[32:35]
    ds_read_b128 v[88:91], v28 offset:1408
    v_mfma_f32_16x16x32_bf16 v[36:39], v[100:103], v[92:95], v[36:39]
    s_waitcnt lgkmcnt(8)
    v_mfma_f32_16x16x32_bf16 v[40:43], v[100:103], v[96:99], v[40:43]
    ds_read_b128 v[68:71], v29 offset:320
    v_mfma_f32_16x16x32_bf16 v[32:35], v[72:75], v[48:51], v[32:35]
    ds_read_b128 v[100:103], v28 offset:896
    v_mfma_f32_16x16x32_bf16 v[36:39], v[72:75], v[104:107], v[36:39]
    s_waitcnt lgkmcnt(8)
    v_mfma_f32_16x16x32_bf16 v[40:43], v[72:75], v[92:95], v[40:43]
    v_mfma_f32_16x16x32_bf16 v[44:47], v[72:75], v[96:99], v[44:47]
    ds_read_b128 v[72:75], v28 offset:384
    v_mfma_f32_16x16x32_bf16 v[32:35], v[76:79], v[52:55], v[32:35]
    v_mfma_f32_16x16x32_bf16 v[36:39], v[76:79], v[48:51], v[36:39]
    ds_read_b128 v[96:99], v28 offset:320
    v_mfma_f32_16x16x32_bf16 v[40:43], v[76:79], v[104:107], v[40:43]
    ds_read_b128 v[52:55], v29 offset:768
    v_mfma_f32_16x16x32_bf16 v[44:47], v[76:79], v[92:95], v[44:47]
    ds_read_b128 v[48:51], v29 offset:256
    s_waitcnt lgkmcnt(8)
    v_mfma_f32_16x16x32_bf16 v[32:35], v[80:83], v[56:59], v[32:35]
    ds_read_b128 v[104:107], v28 offset:832
    v_mfma_f32_16x16x32_bf16 v[36:39], v[80:83], v[84:87], v[36:39]
    ds_read_b128 v[76:79], v29 offset:1280
    v_mfma_f32_16x16x32_bf16 v[40:43], v[80:83], v[60:63], v[40:43]
    ds_read_b128 v[92:95], v28 offset:1344
    s_waitcnt lgkmcnt(9)
    v_mfma_f32_16x16x32_bf16 v[44:47], v[80:83], v[64:67], v[44:47]
    ds_read_b128 v[56:59], v29 offset:1792
    v_mfma_f32_16x16x32_bf16 v[32:35], v[88:91], v[84:87], v[32:35]
    v_mfma_f32_16x16x32_bf16 v[36:39], v[88:91], v[60:63], v[36:39]
    s_waitcnt lgkmcnt(8)
    v_mfma_f32_16x16x32_bf16 v[40:43], v[88:91], v[64:67], v[40:43]
    ds_read_b128 v[80:83], v28 offset:1856
    v_mfma_f32_16x16x32_bf16 v[44:47], v[88:91], v[68:71], v[44:47]
    ds_read_b128 v[84:87], v29 offset:2304
    v_mfma_f32_16x16x32_bf16 v[32:35], v[100:103], v[60:63], v[32:35]
    s_waitcnt lgkmcnt(9)
    v_mfma_f32_16x16x32_bf16 v[36:39], v[100:103], v[64:67], v[36:39]
    v_mfma_f32_16x16x32_bf16 v[40:43], v[100:103], v[68:71], v[40:43]
    ds_read_b128 v[88:91], v28 offset:1792
    v_mfma_f32_16x16x32_bf16 v[32:35], v[72:75], v[64:67], v[32:35]
    ds_read_b128 v[60:63], v29 offset:2240
    s_waitcnt lgkmcnt(8)
    v_mfma_f32_16x16x32_bf16 v[36:39], v[72:75], v[68:71], v[36:39]
    ds_read_b128 v[100:103], v29 offset:1728
    v_mfma_f32_16x16x32_bf16 v[32:35], v[96:99], v[52:55], v[32:35]
    ds_read_b128 v[64:67], v29 offset:1216
    v_mfma_f32_16x16x32_bf16 v[36:39], v[96:99], v[48:51], v[36:39]
    ds_read_b128 v[72:75], v29 offset:704
    s_waitcnt lgkmcnt(9)
    v_mfma_f32_16x16x32_bf16 v[32:35], v[104:107], v[76:79], v[32:35]
    ds_read_b128 v[68:71], v28 offset:1280
    v_mfma_f32_16x16x32_bf16 v[36:39], v[104:107], v[52:55], v[36:39]
    v_mfma_f32_16x16x32_bf16 v[40:43], v[104:107], v[48:51], v[40:43]
    ds_read_b128 v[96:99], v29 offset:192
    s_waitcnt lgkmcnt(9)
    v_mfma_f32_16x16x32_bf16 v[32:35], v[92:95], v[56:59], v[32:35]
    ds_read_b128 v[104:107], v28 offset:768
    v_mfma_f32_16x16x32_bf16 v[36:39], v[92:95], v[76:79], v[36:39]
    v_mfma_f32_16x16x32_bf16 v[40:43], v[92:95], v[52:55], v[40:43]
    s_waitcnt lgkmcnt(8)
    v_mfma_f32_16x16x32_bf16 v[44:47], v[92:95], v[48:51], v[44:47]
    ds_read_b128 v[92:95], v28 offset:256
    v_mfma_f32_16x16x32_bf16 v[32:35], v[80:83], v[84:87], v[32:35]
    v_mfma_f32_16x16x32_bf16 v[36:39], v[80:83], v[56:59], v[36:39]
    ds_read_b128 v[48:51], v28 offset:192
    s_waitcnt lgkmcnt(8)
    v_mfma_f32_16x16x32_bf16 v[40:43], v[80:83], v[76:79], v[40:43]
    ds_read_b128 v[84:87], v29 offset:640
    v_mfma_f32_16x16x32_bf16 v[44:47], v[80:83], v[52:55], v[44:47]
    ds_read_b128 v[56:59], v29 offset:128
    v_mfma_f32_16x16x32_bf16 v[32:35], v[88:91], v[60:63], v[32:35]
    ds_read_b128 v[76:79], v28 offset:704
    s_waitcnt lgkmcnt(8)
    v_mfma_f32_16x16x32_bf16 v[36:39], v[88:91], v[100:103], v[36:39]
    ds_read_b128 v[80:83], v29 offset:1152
    v_mfma_f32_16x16x32_bf16 v[40:43], v[88:91], v[64:67], v[40:43]
    ds_read_b128 v[52:55], v28 offset:1216
    v_mfma_f32_16x16x32_bf16 v[44:47], v[88:91], v[72:75], v[44:47]
    ds_read_b128 v[60:63], v29 offset:1664
    s_waitcnt lgkmcnt(10)
    v_mfma_f32_16x16x32_bf16 v[32:35], v[68:71], v[100:103], v[32:35]
    v_mfma_f32_16x16x32_bf16 v[36:39], v[68:71], v[64:67], v[36:39]
    v_mfma_f32_16x16x32_bf16 v[40:43], v[68:71], v[72:75], v[40:43]
    ds_read_b128 v[88:91], v28 offset:1728
    s_waitcnt lgkmcnt(9)
    v_mfma_f32_16x16x32_bf16 v[44:47], v[68:71], v[96:99], v[44:47]
    ds_read_b128 v[100:103], v29 offset:2176
    v_mfma_f32_16x16x32_bf16 v[32:35], v[104:107], v[64:67], v[32:35]
    v_mfma_f32_16x16x32_bf16 v[36:39], v[104:107], v[72:75], v[36:39]
    s_waitcnt lgkmcnt(9)
    v_mfma_f32_16x16x32_bf16 v[40:43], v[104:107], v[96:99], v[40:43]
    ds_read_b128 v[68:71], v28 offset:1664
    v_mfma_f32_16x16x32_bf16 v[32:35], v[92:95], v[72:75], v[32:35]
    ds_read_b128 v[64:67], v29 offset:2112
    v_mfma_f32_16x16x32_bf16 v[36:39], v[92:95], v[96:99], v[36:39]
    ds_read_b128 v[104:107], v29 offset:1600
    s_waitcnt lgkmcnt(7)
    v_mfma_f32_16x16x32_bf16 v[32:35], v[48:51], v[84:87], v[32:35]
    ds_read_b128 v[72:75], v29 offset:1088
    v_mfma_f32_16x16x32_bf16 v[36:39], v[48:51], v[56:59], v[36:39]
    ds_read_b128 v[92:95], v29 offset:576
    v_mfma_f32_16x16x32_bf16 v[32:35], v[76:79], v[80:83], v[32:35]
    ds_read_b128 v[96:99], v28 offset:1152
    s_waitcnt lgkmcnt(8)
    v_mfma_f32_16x16x32_bf16 v[36:39], v[76:79], v[84:87], v[36:39]
    v_mfma_f32_16x16x32_bf16 v[40:43], v[76:79], v[56:59], v[40:43]
    ds_read_b128 v[48:51], v29 offset:64
    v_mfma_f32_16x16x32_bf16 v[32:35], v[52:55], v[60:63], v[32:35]
    ds_read_b128 v[76:79], v28 offset:640
    v_mfma_f32_16x16x32_bf16 v[36:39], v[52:55], v[80:83], v[36:39]
    v_mfma_f32_16x16x32_bf16 v[40:43], v[52:55], v[84:87], v[40:43]
    v_mfma_f32_16x16x32_bf16 v[44:47], v[52:55], v[56:59], v[44:47]
    ds_read_b128 v[52:55], v28 offset:128
    s_waitcnt lgkmcnt(9)
    v_mfma_f32_16x16x32_bf16 v[32:35], v[88:91], v[100:103], v[32:35]
    v_mfma_f32_16x16x32_bf16 v[36:39], v[88:91], v[60:63], v[36:39]
    ds_read_b128 v[56:59], v28 offset:64
    v_mfma_f32_16x16x32_bf16 v[40:43], v[88:91], v[80:83], v[40:43]
    ds_read_b128 v[100:103], v29 offset:512
    s_waitcnt lgkmcnt(8)
    v_mfma_f32_16x16x32_bf16 v[44:47], v[88:91], v[84:87], v[44:47]
    ds_read_b128 v[60:63], v29 offset:0
    v_mfma_f32_16x16x32_bf16 v[32:35], v[68:71], v[64:67], v[32:35]
    ds_read_b128 v[80:83], v28 offset:576
    v_mfma_f32_16x16x32_bf16 v[36:39], v[68:71], v[104:107], v[36:39]
    ds_read_b128 v[88:91], v29 offset:1024
    s_waitcnt lgkmcnt(8)
    v_mfma_f32_16x16x32_bf16 v[40:43], v[68:71], v[72:75], v[40:43]
    ds_read_b128 v[84:87], v28 offset:1088
    v_mfma_f32_16x16x32_bf16 v[44:47], v[68:71], v[92:95], v[44:47]
    ds_read_b128 v[64:67], v29 offset:1536
    v_mfma_f32_16x16x32_bf16 v[32:35], v[96:99], v[104:107], v[32:35]
    s_waitcnt lgkmcnt(9)
    v_mfma_f32_16x16x32_bf16 v[36:39], v[96:99], v[72:75], v[36:39]
    v_mfma_f32_16x16x32_bf16 v[40:43], v[96:99], v[92:95], v[40:43]
    ds_read_b128 v[68:71], v28 offset:1600
    v_mfma_f32_16x16x32_bf16 v[44:47], v[96:99], v[48:51], v[44:47]
    ds_read_b128 v[104:107], v29 offset:2048
    s_waitcnt lgkmcnt(10)
    v_mfma_f32_16x16x32_bf16 v[32:35], v[76:79], v[72:75], v[32:35]
    v_mfma_f32_16x16x32_bf16 v[36:39], v[76:79], v[92:95], v[36:39]
    v_mfma_f32_16x16x32_bf16 v[40:43], v[76:79], v[48:51], v[40:43]
    s_waitcnt lgkmcnt(7)
    v_mfma_f32_16x16x32_bf16 v[32:35], v[52:55], v[92:95], v[32:35]
    v_mfma_f32_16x16x32_bf16 v[36:39], v[52:55], v[48:51], v[36:39]
    s_barrier
    ds_read_b128 v[108:111], v27 offset:16640
    v_mfma_f32_16x16x32_bf16 v[32:35], v[56:59], v[100:103], v[32:35]
    s_waitcnt lgkmcnt(5)
    v_mfma_f32_16x16x32_bf16 v[36:39], v[56:59], v[60:63], v[36:39]
    v_mfma_f32_16x16x32_bf16 v[32:35], v[80:83], v[88:91], v[32:35]
    v_mfma_f32_16x16x32_bf16 v[36:39], v[80:83], v[100:103], v[36:39]
    s_waitcnt lgkmcnt(3)
    v_mfma_f32_16x16x32_bf16 v[40:43], v[80:83], v[60:63], v[40:43]
    v_mfma_f32_16x16x32_bf16 v[32:35], v[84:87], v[64:67], v[32:35]
    v_mfma_f32_16x16x32_bf16 v[36:39], v[84:87], v[88:91], v[36:39]
    s_waitcnt lgkmcnt(1)
    v_mfma_f32_16x16x32_bf16 v[40:43], v[84:87], v[100:103], v[40:43]
    v_mfma_f32_16x16x32_bf16 v[44:47], v[84:87], v[60:63], v[44:47]
    v_mfma_f32_16x16x32_bf16 v[32:35], v[68:71], v[104:107], v[32:35]
    v_mfma_f32_16x16x32_bf16 v[36:39], v[68:71], v[64:67], v[36:39]
    v_mfma_f32_16x16x32_bf16 v[40:43], v[68:71], v[88:91], v[40:43]
    v_mfma_f32_16x16x32_bf16 v[44:47], v[68:71], v[100:103], v[44:47]
    s_waitcnt lgkmcnt(0)
    s_nop 3
    v_add_f32 v108, v108, v32
    v_add_f32 v109, v109, v33
    v_add_f32 v110, v110, v34
    v_add_f32 v111, v111, v35
    v_cvt_pk_bf16_f32 v4, v108, v109
    v_cvt_pk_bf16_f32 v5, v110, v111
    buffer_store_dwordx2 v[4:5], v30, s[8:11], s43 offen offset:0 sc1
    v_cvt_pk_bf16_f32 v6, v36, v37
    v_cvt_pk_bf16_f32 v7, v38, v39
    buffer_store_dwordx2 v[6:7], v30, s[8:11], s44 offen offset:3072 sc1
    v_cvt_pk_bf16_f32 v8, v40, v41
    v_cvt_pk_bf16_f32 v9, v42, v43
    buffer_store_dwordx2 v[8:9], v30, s[8:11], s44 offen offset:2048 sc1
    v_cvt_pk_bf16_f32 v10, v44, v45
    v_cvt_pk_bf16_f32 v11, v46, v47
    buffer_store_dwordx2 v[10:11], v30, s[8:11], s44 offen offset:1024 sc1
    s_endpgm
L_help:
    s_setprio 2
    ds_read2_b32 v[48:49], v41 offset0:6 offset1:7
    ds_read2_b32 v[50:51], v41 offset0:4 offset1:5
    ds_read2_b32 v[52:53], v41 offset0:2 offset1:3
    ds_read2_b32 v[54:55], v41 offset0:0 offset1:1
    ds_read2_b32 v[56:57], v41 offset0:38 offset1:39
    ds_read2_b32 v[58:59], v41 offset0:36 offset1:37
    ds_read2_b32 v[60:61], v41 offset0:34 offset1:35
    ds_read2_b32 v[62:63], v41 offset0:32 offset1:33
    ds_read2_b32 v[64:65], v41 offset0:70 offset1:71
    ds_read2_b32 v[66:67], v41 offset0:68 offset1:69
    ds_read2_b32 v[68:69], v41 offset0:66 offset1:67
    ds_read2_b32 v[70:71], v41 offset0:64 offset1:65
    ds_read2_b32 v[72:73], v41 offset0:102 offset1:103
    ds_read2_b32 v[74:75], v41 offset0:100 offset1:101
    ds_read2_b32 v[76:77], v41 offset0:98 offset1:99
    ds_read2_b32 v[78:79], v41 offset0:96 offset1:97
    ds_read_b32 v104, v30 offset:2624
    ds_read_b32 v105, v30 offset:2620
    s_mov_b32 exec_lo, 0x70007
    s_mov_b32 exec_hi, 0x70007
    ds_write_b128 v29, v[120:123] offset:1984
    ds_write_b128 v29, v[120:123] offset:4096
    s_mov_b64 exec, -1
    v_cmp_lt_u32 s[40:41], 2, v27
    v_cmp_lt_u32 s[48:49], 1, v27
    v_cmp_eq_u32 s[50:51], 9, v27
    s_waitcnt lgkmcnt(0)
    v_cndmask_b32 v4, 0, v104, s[40:41]
    v_cndmask_b32 v5, 0, v104, s[48:49]
    v_cndmask_b32 v5, v5, v105, s[50:51]
    v_cvt_pk_bf16_f32 v4, v4, v5
    s_mov_b64 exec, 0xffff
    ds_write_b32 v28, v4 offset:2032
    s_mov_b64 exec, -1
    s_lshl_b32 s3, s24, 9
    s_sub_u32 s3, s3, 4096
    v_add_u32 v15, s3, v15
    s_cmp_eq_u32 s33, 0
    s_cbranch_scc1 L_uhave
    s_waitcnt vmcnt(0)
    s_mov_b64 exec, 0xffff
    v_cmp_ne_u64 vcc, v[16:17], v[12:13]
    s_mov_b64 exec, -1
    s_cbranch_vccz L_h1b_done
    s_mov_b32 s42, 1000000
    s_mov_b64 exec, 0xffff
L_h1b:
    v_mov_b32 v4, 0
    v_mov_b32 v5, 0
    buffer_atomic_or_x2 v[4:5], v22, s[8:11], s39 offen sc0 sc1
    s_waitcnt vmcnt(0)
    v_cmp_ne_u64 vcc, v[4:5], v[12:13]
    s_sub_u32 s42, s42, 1
    s_cbranch_scc1 L_h1b_out
    s_cbranch_vccnz L_h1b
L_h1b_out:
    s_mov_b64 exec, -1
L_h1b_done:
    buffer_load_dwordx4 v[96:99], v1, s[8:11], s47 offen sc1
    buffer_load_dwordx4 v[100:103], v1, s[8:11], s47 offen offset:1024 sc1
L_uhave:
    s_waitcnt lgkmcnt(0)
    s_barrier
    v_cmp_gt_u32 vcc, 258, v0
    s_nop 0
    s_and_saveexec_b64 s[40:41], vcc
    ds_write_b64 v15, v[120:121] offset:576
    s_mov_b64 exec, -1
    s_waitcnt vmcnt(1)
    ds_write_b128 v15, v[96:99] offset:5280
    ds_write_b64 v15, v[96:97] offset:584
    ds_write_b64 v15, v[98:99] offset:592
    s_waitcnt vmcnt(0)
    ds_write_b128 v15, v[100:103] offset:5792
    ds_write_b64 v15, v[100:101] offset:1096
    ds_write_b64 v15, v[102:103] offset:1104
    s_waitcnt lgkmcnt(0)
    s_barrier
    v_mov_b32 v116, -1
    v_mov_b32 v117, -1
    v_mov_b32 v118, -1
    v_mov_b32 v119, -1
    buffer_store_dwordx4 v[116:119], v1, s[8:11], s47 offen sc1
    buffer_store_dwordx4 v[116:119], v1, s[8:11], s47 offen offset:1024 sc1
    s_lshr_b32 s3, s25, 5
    s_lshl_b32 s3, s3, 2
    s_add_u32 s3, s3, s24
    s_lshl_b32 s3, s3, 8
    s_and_b32 s33, s25, 31
    s_lshl_b32 s33, s33, 3
    s_add_u32 s3, s3, s33
    s_add_u32 s3, s3, 0x445c00
    ds_read_b128 v[96:99], v42 offset:0
    ds_read_b128 v[100:103], v42 offset:512
    ds_read_b128 v[104:107], v42 offset:1024
    ds_read_b128 v[108:111], v42 offset:1536
    v_cvt_pk_bf16_f32 v80, v48, v49
    v_cvt_pk_bf16_f32 v81, v50, v51
    v_cvt_pk_bf16_f32 v82, v52, v53
    v_cvt_pk_bf16_f32 v83, v54, v55
    v_cvt_pk_bf16_f32 v84, v56, v57
    v_cvt_pk_bf16_f32 v85, v58, v59
    v_cvt_pk_bf16_f32 v86, v60, v61
    v_cvt_pk_bf16_f32 v87, v62, v63
    v_cvt_pk_bf16_f32 v88, v64, v65
    v_cvt_pk_bf16_f32 v89, v66, v67
    v_cvt_pk_bf16_f32 v90, v68, v69
    v_cvt_pk_bf16_f32 v91, v70, v71
    v_cvt_pk_bf16_f32 v92, v72, v73
    v_cvt_pk_bf16_f32 v93, v74, v75
    v_cvt_pk_bf16_f32 v94, v76, v77
    v_cvt_pk_bf16_f32 v95, v78, v79
    v_cmp_le_i32 vcc, 0, v40
    s_nop 1
    v_cndmask_b32 v80, 0, v80, vcc
    v_cmp_le_i32 vcc, 1, v40
    s_nop 1
    v_cndmask_b32 v81, 0, v81, vcc
    v_cmp_le_i32 vcc, 2, v40
    s_nop 1
    v_cndmask_b32 v82, 0, v82, vcc
    v_cmp_le_i32 vcc, 3, v40
    s_nop 1
    v_cndmask_b32 v83, 0, v83, vcc
    s_waitcnt lgkmcnt(3)
    v_mfma_f32_16x16x32_bf16 v[48:51], v[96:99], v[32:35], 0
    v_mfma_f32_16x16x32_bf16 v[52:55], v[96:99], v[36:39], 0
    s_waitcnt lgkmcnt(2)
    v_mfma_f32_16x16x32_bf16 v[56:59], v[100:103], v[32:35], 0
    v_mfma_f32_16x16x32_bf16 v[60:63], v[100:103], v[36:39], 0
    s_waitcnt lgkmcnt(1)
    v_mfma_f32_16x16x32_bf16 v[64:67], v[104:107], v[32:35], 0
    v_mfma_f32_16x16x32_bf16 v[68:71], v[104:107], v[36:39], 0
    s_waitcnt lgkmcnt(0)
    v_mfma_f32_16x16x32_bf16 v[72:75], v[108:111], v[32:35], 0
    v_mfma_f32_16x16x32_bf16 v[76:79], v[108:111], v[36:39], 0
    v_cvt_pk_bf16_f32 v96, v48, v52
    v_cvt_pk_bf16_f32 v97, v49, v53
    v_cvt_pk_bf16_f32 v98, v50, v54
    v_cvt_pk_bf16_f32 v99, v51, v55
    v_cvt_pk_bf16_f32 v100, v56, v60
    v_cvt_pk_bf16_f32 v101, v57, v61
    v_cvt_pk_bf16_f32 v102, v58, v62
    v_cvt_pk_bf16_f32 v103, v59, v63
    v_cvt_pk_bf16_f32 v104, v64, v68
    v_cvt_pk_bf16_f32 v105, v65, v69
    v_cvt_pk_bf16_f32 v106, v66, v70
    v_cvt_pk_bf16_f32 v107, v67, v71
    v_cvt_pk_bf16_f32 v108, v72, v76
    v_cvt_pk_bf16_f32 v109, v73, v77
    v_cvt_pk_bf16_f32 v110, v74, v78
    v_cvt_pk_bf16_f32 v111, v75, v79
    v_mfma_f32_16x16x32_bf16 v[48:51], v[96:99], v[92:95], 0
    v_mfma_f32_16x16x32_bf16 v[52:55], v[96:99], v[84:87], 0
    v_mfma_f32_16x16x32_bf16 v[48:51], v[100:103], v[88:91], v[48:51]
    v_mfma_f32_16x16x32_bf16 v[52:55], v[100:103], v[80:83], v[52:55]
    v_mfma_f32_16x16x32_bf16 v[48:51], v[104:107], v[84:87], v[48:51]
    v_mfma_f32_16x16x32_bf16 v[48:51], v[108:111], v[80:83], v[48:51]
    s_nop 5
    ds_write_b128 v43, v[52:55] offset:17664
    s_nop 0
    ds_write_b128 v43, v[48:51] offset:19712
    s_waitcnt vmcnt(0) lgkmcnt(0)
    s_mov_b64 exec, 0x1
    buffer_store_dwordx2 v[12:13], off, s[8:11], s3 sc1
    s_mov_b64 exec, -1
    s_barrier
    s_endpgm
L_p2:
    s_and_b32 s25, s2, 7
    s_lshl_b32 s25, s25, 1
    s_bfe_u32 s3, s2, 0x10003
    s_add_u32 s25, s25, s3
    s_load_dwordx2 s[16:17], s[0:1], 8
    s_load_dwordx2 s[20:21], s[0:1], 16
    s_mov_b32 s18, 0x101000
    s_mov_b32 s19, 0x20000
    s_mov_b32 s22, 0x101000
    s_mov_b32 s23, 0x20000
    v_and_b32 v4, 3, v2
    v_lshrrev_b32 v5, 2, v2
    v_lshl_add_u32 v4, v4, 2, v5
    v_lshl_add_u32 v4, v4, 3, s24
    v_cvt_f32_u32 v4, v4
    v_cvt_f32_u32 v5, v3
    v_mul_f32 v4, 0x3c000000, v4
    v_mul_f32 v6, 4.0, v5
    v_mul_f32 v6, v6, v4
    v_add_f32 v8, v6, v4
    v_fma_f32 v9, 2.0, v4, v6
    v_fma_f32 v10, 2.0, v4, v8
    v_cos_f32 v116, v6
    v_sin_f32 v120, v6
    v_cos_f32 v117, v8
    v_sin_f32 v121, v8
    v_cos_f32 v118, v9
    v_sin_f32 v122, v9
    v_cos_f32 v119, v10
    v_sin_f32 v123, v10
    v_cvt_pk_bf16_f32 v50, v120, v121
    v_cvt_pk_bf16_f32 v51, v122, v123
    v_cvt_pk_bf16_f32 v52, v116, v117
    v_cvt_pk_bf16_f32 v53, v118, v119
    v_cvt_pk_bf16_f32 v54, -v120, -v121
    v_cvt_pk_bf16_f32 v55, -v122, -v123
    v_lshrrev_b32 v4, 1, v3
    v_and_b32 v5, 1, v3
    v_lshlrev_b32 v6, 10, v5
    v_lshl_add_u32 v6, v4, 4, v6
    v_mul_u32_u24 v6, 514, v6
    v_lshl_add_u32 v60, v2, 2, v6
    s_lshl_b32 s27, s24, 5
    s_add_u32 s27, s27, s25
    s_mul_i32 s27, s27, 514
    s_lshl_b32 s3, s26, 6
    s_add_u32 s27, s27, s3
    s_add_u32 s28, s27, 131584
    s_add_u32 s29, s27, 263168
    s_add_u32 s30, s27, 394752
    v_mul_u32_u24 v56, 528, v2
    v_lshl_add_u32 v56, v3, 4, v56
    s_lshl_b32 s3, s24, 6
    v_add_u32 v56, s3, v56
    v_mul_u32_u24 v57, 528, v4
    v_and_b32 v6, 0x1f0, v1
    v_add_u32 v57, v57, v6
    s_mul_i32 s3, s24, 1056
    v_add_u32 v57, s3, v57
    v_and_b32 v7, 7, v2
    v_mul_u32_u24 v58, 1040, v7
    v_lshrrev_b32 v8, 3, v2
    v_lshl_add_u32 v58, v8, 6, v58
    v_lshl_add_u32 v58, v3, 4, v58
    s_lshl_b32 s3, s24, 7
    v_add_u32 v58, s3, v58
    v_cmp_eq_u32 vcc, v4, v8
    s_waitcnt lgkmcnt(0)
    v_lshl_add_u64 v[124:125], s[56:57], 0, 1
    v_lshl_add_u64 v[12:13], s[58:59], 0, 1
    v_lshlrev_b32 v10, 13, v2
    s_waitcnt vmcnt(0)
    s_mov_b32 exec_lo, s41
    s_mov_b32 exec_hi, 0
    buffer_store_dwordx2 v[124:125], v10, s[8:11], s46 offen sc1
    s_mov_b64 exec, -1
    s_waitcnt lgkmcnt(0)
    s_barrier
    buffer_load_dword v72, v60, s[16:19], s27 offen
    buffer_load_dword v76, v60, s[20:23], s27 offen
    buffer_load_dword v73, v60, s[16:19], s28 offen
    buffer_load_dword v77, v60, s[20:23], s28 offen
    buffer_load_dword v74, v60, s[16:19], s29 offen
    buffer_load_dword v78, v60, s[20:23], s29 offen
    buffer_load_dword v75, v60, s[16:19], s30 offen
    buffer_load_dword v79, v60, s[20:23], s30 offen
    v_cvt_f32_u32 v4, v7
    v_cvt_f32_u32 v5, v5
    v_mul_f32 v4, 0x3e000000, v4
    v_mul_f32 v5, 4.0, v5
    v_mul_f32 v6, v5, v4
    v_add_f32 v8, v6, v4
    v_fma_f32 v9, 2.0, v4, v6
    v_fma_f32 v10, 2.0, v4, v8
    v_cos_f32 v116, v6
    v_sin_f32 v120, v6
    v_cos_f32 v117, v8
    v_sin_f32 v121, v8
    v_cos_f32 v118, v9
    v_sin_f32 v122, v9
    v_cos_f32 v119, v10
    v_sin_f32 v123, v10
    v_mov_b32 v4, 0x3ab504f3
    v_cndmask_b32 v4, 0, v4, vcc
    v_mul_f32 v116, v4, v116
    v_mul_f32 v117, v4, v117
    v_mul_f32 v118, v4, v118
    v_mul_f32 v119, v4, v119
    v_mul_f32 v120, v4, v120
    v_mul_f32 v121, v4, v121
    v_mul_f32 v122, v4, v122
    v_mul_f32 v123, v4, v123
    v_cvt_pk_bf16_f32 v40, -v120, -v121
    v_cvt_pk_bf16_f32 v41, -v122, -v123
    v_cvt_pk_bf16_f32 v42, v116, v117
    v_cvt_pk_bf16_f32 v43, v118, v119
    v_cvt_pk_bf16_f32 v44, v120, v121
    v_cvt_pk_bf16_f32 v45, v122, v123
    v_mov_b32 v46, v42
    v_mov_b32 v47, v43
    v_mov_b32 v48, v40
    v_mov_b32 v49, v41
    s_lshl_b32 s3, s24, 11
    s_add_u32 s3, s3, 16896
    v_xor_b32 v6, v2, v3
    v_and_b32 v6, 3, v6
    v_lshlrev_b32 v6, 5, v6
    v_lshl_add_u32 v6, v2, 7, v6
    v_add_u32 v6, s3, v6
    ds_write_b128 v6, v[50:53]
    ds_write_b64 v6, v[54:55] offset:16
    v_bfe_u32 v4, v0, 3, 1
    v_xor_b32 v5, v4, v0
    v_lshl_add_u32 v4, v3, 2, v4
    v_and_b32 v5, 3, v5
    v_lshlrev_b32 v5, 5, v5
    v_lshl_add_u32 v4, v4, 7, v5
    v_and_b32 v5, 4, v0
    v_lshlrev_b32 v5, 1, v5
    v_bitop3_b32 v4, v4, v5, 8 bitop3:0x96
    v_add_u32 v7, s3, v4
    v_xor_b32 v8, 64, v7
    ds_read_b64_tr_b16 v[32:33], v7 offset:0
    ds_read_b64_tr_b16 v[34:35], v8 offset:256
    ds_read_b64_tr_b16 v[36:37], v7 offset:8
    ds_read_b64_tr_b16 v[38:39], v8 offset:264
    v_lshlrev_b32 v11, 3, v2
    v_lshl_add_u32 v126, v3, 7, v11
    s_mul_i32 s74, s25, 131072
    s_lshl_b32 s3, s24, 11
    s_add_u32 s74, s74, s3
    s_lshl_b32 s3, s26, 14
    s_add_u32 s74, s74, s3
    s_lshl_b32 s78, s24, 7
    s_add_u32 s78, s78, 0x440000
    s_lshl_b32 s39, s26, 10
    s_add_u32 s39, s39, s78
    s_and_b32 s3, s25, 1
    s_lshl_b32 s3, s3, 13
    s_add_u32 s39, s39, s3
    s_setprio 3
    s_waitcnt vmcnt(0) lgkmcnt(0)
    v_lshlrev_b32 v64, 16, v72
    v_and_b32 v72, 0xffff0000, v72
    v_lshlrev_b32 v65, 16, v73
    v_and_b32 v73, 0xffff0000, v73
    v_lshlrev_b32 v66, 16, v74
    v_and_b32 v74, 0xffff0000, v74
    v_lshlrev_b32 v67, 16, v75
    v_and_b32 v75, 0xffff0000, v75
    v_lshlrev_b32 v68, 16, v76
    v_and_b32 v76, 0xffff0000, v76
    v_lshlrev_b32 v69, 16, v77
    v_and_b32 v77, 0xffff0000, v77
    v_lshlrev_b32 v70, 16, v78
    v_and_b32 v78, 0xffff0000, v78
    v_lshlrev_b32 v71, 16, v79
    v_and_b32 v79, 0xffff0000, v79
    s_mov_b32 s42, 1000000
    s_mov_b64 exec, 0xffff
L_h1a:
    v_mov_b32 v4, 0
    v_mov_b32 v5, 0
    buffer_atomic_or_x2 v[4:5], v11, s[8:11], s39 offen sc0 sc1
    s_waitcnt vmcnt(0)
    v_cmp_ne_u64 vcc, v[4:5], v[12:13]
    s_sub_u32 s42, s42, 1
    s_cbranch_scc1 L_h1a_out
    s_cbranch_vccnz L_h1a
L_h1a_out:
    s_mov_b64 exec, -1
L_h1a_done:
    buffer_load_dwordx2 v[88:89], v126, s[8:11], s74 offen offset:0 sc1
    buffer_load_dwordx2 v[92:93], v126, s[8:11], s74 offen offset:512 sc1
    buffer_load_dwordx2 v[90:91], v126, s[8:11], s74 offen offset:1024 sc1
    buffer_load_dwordx2 v[94:95], v126, s[8:11], s74 offen offset:1536 sc1
    s_waitcnt vmcnt(0)
    v_swap_b32 v89, v92
    v_swap_b32 v91, v94
    s_nop 1
    v_mfma_f32_16x16x32_bf16 v[100:103], v[88:91], v[32:35], 0
    v_mfma_f32_16x16x32_bf16 v[104:107], v[88:91], v[36:39], 0
    v_mfma_f32_16x16x32_bf16 v[108:111], v[92:95], v[32:35], 0
    v_mfma_f32_16x16x32_bf16 v[112:115], v[92:95], v[36:39], 0
    s_nop 4
    v_cvt_pk_bf16_f32 v88, v100, v101
    v_cvt_pk_bf16_f32 v89, v102, v103
    v_cvt_pk_bf16_f32 v90, v104, v105
    v_cvt_pk_bf16_f32 v91, v106, v107
    ds_write_b128 v56, v[88:91] offset:0
    v_cvt_pk_bf16_f32 v92, v108, v109
    v_cvt_pk_bf16_f32 v93, v110, v111
    v_cvt_pk_bf16_f32 v94, v112, v113
    v_cvt_pk_bf16_f32 v95, v114, v115
    ds_write_b128 v56, v[92:95] offset:8448
L_x1:
    s_waitcnt lgkmcnt(0)
    s_barrier
    ds_read_b64_tr_b16 v[88:89], v57 offset:0
    ds_read_b64_tr_b16 v[90:91], v57 offset:8
    ds_read_b64_tr_b16 v[92:93], v57 offset:8448
    ds_read_b64_tr_b16 v[94:95], v57 offset:8456
    s_waitcnt lgkmcnt(2)
    v_mfma_f32_16x16x32_bf16 v[100:103], v[42:45], v[88:91], 0
    v_mfma_f32_16x16x32_bf16 v[104:107], v[40:43], v[88:91], 0
    s_waitcnt lgkmcnt(0)
    v_mfma_f32_16x16x32_bf16 v[108:111], v[42:45], v[92:95], 0
    v_mfma_f32_16x16x32_bf16 v[112:115], v[40:43], v[92:95], 0
    s_nop 3
    v_mul_f32 v80, v100, v64
    v_mul_f32 v84, v100, v68
    v_mul_f32 v81, v101, v65
    v_mul_f32 v85, v101, v69
    v_mul_f32 v82, v102, v66
    v_mul_f32 v86, v102, v70
    v_mul_f32 v83, v103, v67
    v_mul_f32 v87, v103, v71
    v_fma_f32 v80, -v104, v68, v80
    v_fmac_f32 v84, v104, v64
    v_fma_f32 v81, -v105, v69, v81
    v_fmac_f32 v85, v105, v65
    v_fma_f32 v82, -v106, v70, v82
    v_fmac_f32 v86, v106, v66
    v_fma_f32 v83, -v107, v71, v83
    v_fmac_f32 v87, v107, v67
    v_cvt_pk_bf16_f32 v88, v80, v81
    v_cvt_pk_bf16_f32 v89, v82, v83
    v_cvt_pk_bf16_f32 v90, v84, v85
    v_cvt_pk_bf16_f32 v91, v86, v87
    s_nop 1
    v_mfma_f32_16x16x32_bf16 v[100:103], v[88:91], v[46:49], 0
    v_mfma_f32_16x16x32_bf16 v[104:107], v[88:91], v[44:47], 0
    v_mul_f32 v80, v108, v72
    v_mul_f32 v84, v108, v76
    v_mul_f32 v81, v109, v73
    v_mul_f32 v85, v109, v77
    v_mul_f32 v82, v110, v74
    v_mul_f32 v86, v110, v78
    v_mul_f32 v83, v111, v75
    v_mul_f32 v87, v111, v79
    v_fma_f32 v80, -v112, v76, v80
    v_fmac_f32 v84, v112, v72
    v_fma_f32 v81, -v113, v77, v81
    v_fmac_f32 v85, v113, v73
    v_fma_f32 v82, -v114, v78, v82
    v_fmac_f32 v86, v114, v74
    v_fma_f32 v83, -v115, v79, v83
    v_fmac_f32 v87, v115, v75
    v_cvt_pk_bf16_f32 v92, v80, v81
    v_cvt_pk_bf16_f32 v93, v82, v83
    v_cvt_pk_bf16_f32 v94, v84, v85
    v_cvt_pk_bf16_f32 v95, v86, v87
    s_nop 1
    v_mfma_f32_16x16x32_bf16 v[108:111], v[92:95], v[46:49], 0
    v_mfma_f32_16x16x32_bf16 v[112:115], v[92:95], v[44:47], 0
    v_cvt_pk_bf16_f32 v88, v100, v101
    v_cvt_pk_bf16_f32 v89, v102, v103
    v_cvt_pk_bf16_f32 v90, v104, v105
    v_cvt_pk_bf16_f32 v91, v106, v107
    ds_write_b128 v58, v[88:91] offset:16896
    s_nop 1
    v_cvt_pk_bf16_f32 v92, v108, v109
    v_cvt_pk_bf16_f32 v93, v110, v111
    v_cvt_pk_bf16_f32 v94, v112, v113
    v_cvt_pk_bf16_f32 v95, v114, v115
    ds_write_b128 v58, v[92:95] offset:25216
L_x3:
    s_waitcnt lgkmcnt(0)
    s_barrier
    ds_read_b64_tr_b16 v[88:89], v15 offset:16896
    ds_read_b64_tr_b16 v[90:91], v15 offset:16904
    ds_read_b64_tr_b16 v[92:93], v15 offset:25216
    ds_read_b64_tr_b16 v[94:95], v15 offset:25224
    s_waitcnt lgkmcnt(2)
    v_mfma_f32_16x16x32_bf16 v[100:103], v[52:55], v[88:91], 0
    v_mfma_f32_16x16x32_bf16 v[104:107], v[50:53], v[88:91], 0
    s_waitcnt lgkmcnt(0)
    v_mfma_f32_16x16x32_bf16 v[108:111], v[52:55], v[92:95], 0
    v_mfma_f32_16x16x32_bf16 v[112:115], v[50:53], v[92:95], 0
    s_nop 4
    v_cvt_pk_bf16_f32 v88, v100, v104
    v_cvt_pk_bf16_f32 v90, v101, v105
    v_cvt_pk_bf16_f32 v92, v102, v106
    v_cvt_pk_bf16_f32 v94, v103, v107
    v_or_b32 v88, 1, v88
    v_or_b32 v90, 1, v90
    v_or_b32 v92, 1, v92
    v_or_b32 v94, 1, v94
    v_cvt_pk_bf16_f32 v89, v108, v112
    buffer_store_dwordx2 v[88:89], v126, s[8:11], s74 offen offset:0 sc1
    v_cvt_pk_bf16_f32 v91, v109, v113
    buffer_store_dwordx2 v[90:91], v126, s[8:11], s74 offen offset:512 sc1
    v_cvt_pk_bf16_f32 v93, v110, v114
    buffer_store_dwordx2 v[92:93], v126, s[8:11], s74 offen offset:1024 sc1
    v_cvt_pk_bf16_f32 v95, v111, v115
    buffer_store_dwordx2 v[94:95], v126, s[8:11], s74 offen offset:1536 sc1
    s_lshl_b32 s40, s31, 2
    s_lshr_b32 s3, s32, 4
    s_add_u32 s40, s40, s3
    s_lshl_b32 s40, s40, 8
    s_add_u32 s40, s40, 0x446000
    v_add_u32 v7, s38, v1
    v_bfe_u32 v9, v0, 2, 4
    v_and_b32 v10, 48, v14
    v_mul_u32_u24 v24, 80, v9
    v_lshl_add_u32 v9, v9, 11, v10
    s_mul_i32 s3, s24, 2560
    v_add3_u32 v24, v24, v10, s3
    v_mul_u32_u24 v25, 80, v2
    v_lshl_add_u32 v25, v3, 4, v25
    v_add_u32 v25, s3, v25
    s_lshl_b32 s37, s32, 16
    s_lshl_b32 s3, s35, 6
    s_add_u32 s37, s37, s3
    s_add_u32 s37, s37, 1024
    s_add_u32 s36, s37, 0x8000
    s_mov_b32 s42, 1000000
    s_cmp_lg_u32 s24, 0
    s_cbranch_scc1 L_yw_o
    s_lshl_b32 s45, s32, 12
    s_add_u32 s45, s45, s47
    v_lshrrev_b32 v8, 1, v1
    s_mov_b32 exec_hi, 0
L_yw1:
    v_mov_b32 v4, 0
    v_mov_b32 v5, 0
    buffer_atomic_or_x2 v[4:5], v8, s[8:11], s40 offen sc0 sc1
    buffer_load_dword v6, off, s[8:11], s45 sc1
    s_waitcnt vmcnt(0)
    v_cmp_ne_u64 vcc, v[4:5], v[124:125]
    s_sub_u32 s42, s42, 1
    s_cbranch_scc1 L_yw_o
    s_cbranch_vccnz L_yw1
    s_mov_b64 exec, 1
    s_branch L_yw3
L_yw2:
    buffer_load_dword v6, off, s[8:11], s45 sc1
    s_waitcnt vmcnt(0)
L_yw3:
    v_cmp_eq_u32 vcc, -1, v6
    s_sub_u32 s42, s42, 1
    s_cbranch_scc1 L_yw_o
    s_cbranch_vccnz L_yw2
L_yw_o:
    s_mov_b64 exec, -1
    s_mov_b32 s42, 1000000
    s_barrier
L_h2b:
    buffer_load_dwordx4 v[88:91], v27, s[8:11], s47 offen sc1
    buffer_load_dwordx4 v[92:95], v27, s[8:11], s48 offen sc1
    s_waitcnt vmcnt(0)
    v_max3_u32 v4, v88, v89, v90
    v_max3_u32 v5, v91, v92, v93
    v_max3_u32 v4, v4, v94, v95
    v_max_u32 v4, v4, v5
    v_cmp_eq_u32 vcc, -1, v4
    s_nop 0
    s_mov_b64 exec, vcc
    s_sub_u32 s42, s42, 1
    s_cbranch_scc1 L_h2b_done
    s_cbranch_vccnz L_h2b
L_h2b_done:
    s_mov_b64 exec, -1
    ds_write_b128 v7, v[88:91]
    ds_write_b128 v7, v[92:95] offset:1024
    ds_read_b64_tr_b16 v[96:97], v26 offset:0
    ds_read_b64_tr_b16 v[98:99], v26 offset:256
    ds_read_b64_tr_b16 v[100:101], v26 offset:32
    ds_read_b64_tr_b16 v[102:103], v26 offset:288
    s_waitcnt lgkmcnt(2)
    ds_write_b128 v25, v[96:99] offset:33792
    s_waitcnt lgkmcnt(1)
    ds_write_b128 v25, v[100:103] offset:35072
    ds_read_b128 v[88:91], v24 offset:33792
    ds_read_b128 v[92:95], v24 offset:35072
    s_waitcnt lgkmcnt(1)
    buffer_store_dwordx4 v[88:91], v9, s[12:15], s37 offen sc1 nt
    s_waitcnt lgkmcnt(0)
    buffer_store_dwordx4 v[92:95], v9, s[12:15], s36 offen sc1 nt
    s_cmp_ge_u32 s32, 4
    s_cbranch_scc1 L_yt_c
    s_barrier
    s_cmp_lg_u32 s24, 0
    s_cbranch_scc1 L_yt_c
    buffer_store_dwordx2 v[124:125], off, s[8:11], s49 sc1
L_yt_c:
    s_endpgm
L_end:
    s_endpgm
Lcode_end:
.section .rodata,"a"
.p2align 6
.amdhsa_kernel concat_heads__spectral_gfnet__ssm_conv_s4__prompt_kernel
  .amdhsa_next_free_vgpr 128
  .amdhsa_next_free_sgpr 80
  .amdhsa_accum_offset 128
  .amdhsa_group_segment_fixed_size 0
  .amdhsa_kernarg_size 120
  .amdhsa_user_sgpr_count 2
  .amdhsa_user_sgpr_kernarg_segment_ptr 1
  .amdhsa_system_sgpr_workgroup_id_x 1
.end_amdhsa_kernel
```
